```python
import torch

def _softmax(x, axis=-1):
    return torch.softmax(x, dim=axis)

def _gelu(x):
    return torch.nn.functional.gelu(x, approximate='tanh')

def _silu(x):
    return torch.nn.functional.silu(x)

def _sigmoid(x):
    return torch.sigmoid(x)

def _layernorm(x, axis=-1, eps=1e-05):
    m = x.mean(dim=axis, keepdim=True)
    v = x.var(dim=axis, keepdim=True, unbiased=False)
    return (x - m) / torch.sqrt(v + eps)

def _scatter_add(tgt, idx, src, axis=0):
    return tgt.clone().index_add_(axis, idx, src)

def _segment_sum(src, seg, n):
    out = torch.zeros((n,) + src.shape[1:], dtype=src.dtype)
    return out.index_add_(0, seg, src)

def _pad(x, pw):
    flat = tuple((v for pair in reversed(pw) for v in pair))
    return torch.nn.functional.pad(x, flat)
kernel_name = 'adaLN_cond__gqa_block_cached__dense_activation_relu__decode'

def setup_inputs():

    _w = lambda a: (lambda t: t.to(torch.bfloat16) if t.is_floating_point() else t)(torch.as_tensor(a))

    def _A_setup():
        B, Sq, D = (1, 1, 512)
        Hq, Hkv, Sk, Dh = (32, 32, 8192, 128)
        assert Hq % Hkv == 0, (Hq, Hkv)
        return {'x': _w((lambda *s: torch.randn(*s, dtype=torch.bfloat16) * 0.1)(B, Sq, D)), 'k_cache': _w((lambda *s: torch.randn(*s, dtype=torch.bfloat16) * 0.8)(B, Hkv, Sk, Dh)), 'v_cache': _w((lambda *s: torch.randn(*s, dtype=torch.bfloat16) * 0.8)(B, Hkv, Sk, Dh)), 'wq': _w((lambda *s: torch.randn(*s, dtype=torch.bfloat16) * 0.8)(D, Hq * Dh) * D ** (-0.5)), 'wo': _w((lambda *s: torch.randn(*s, dtype=torch.bfloat16) * 0.8)(Hq * Dh, D) * (Hq * Dh) ** (-0.5))}
    _A_in = _A_setup()

    def _B_setup():
        B, S, D, Dff = (1, 1, 512, 1376)
        return {'x': _w((lambda *s: torch.randn(*s, dtype=torch.bfloat16) * 0.1)(B, S, D)), 'w1': _w((lambda *s: torch.randn(*s, dtype=torch.bfloat16) * 0.1)(D, Dff)), 'w2': _w((lambda *s: torch.randn(*s, dtype=torch.bfloat16) * 0.1)(Dff, D))}
    _B_in = _B_setup()
    return {'A_x': _A_in['x'], 'A_k_cache': _A_in['k_cache'], 'A_v_cache': _A_in['v_cache'], 'A_wq': _A_in['wq'], 'A_wo': _A_in['wo'], 'B_x': _B_in['x'], 'B_w1': _B_in['w1'], 'B_w2': _B_in['w2'], 'c': _w((lambda *s: torch.randn(*s, dtype=torch.bfloat16) * 0.4)(1, 512) * 8.0), 'w_mod': _w((lambda *s: torch.randn(*s, dtype=torch.bfloat16) * 0.4)(512, 6 * 512) * 512 ** (-0.5) * 8.0)}

def reference(A_x, A_k_cache, A_v_cache, A_wq, A_wo, B_x, B_w1, B_w2, c, w_mod):

    def _A_ref(x, k_cache, v_cache, wq, wo):
        B, Sq, D = x.shape
        Hq, Dh = (32, 128)
        Hkv = k_cache.shape[1]
        rep = Hq // Hkv
        q = (lambda x, *d: x.permute(*d))((x @ wq).reshape(B, Sq, Hq, Dh), 0, 2, 1, 3)
        k = (lambda x, n, axis: torch.repeat_interleave(x, n, dim=axis))(k_cache, rep, axis=1)
        v = (lambda x, n, axis: torch.repeat_interleave(x, n, dim=axis))(v_cache, rep, axis=1)
        scores = torch.einsum('bhqd,bhkd->bhqk', q, k) * Dh ** (-0.5)
        p = _softmax(scores, axis=-1)
        o = torch.einsum('bhqk,bhkd->bhqd', p, v)
        return (lambda x, *d: x.permute(*d))(o, 0, 2, 1, 3).reshape(B, Sq, Hq * Dh) @ wo

    def _B_ref(x, w1, w2):
        h = torch.einsum('bsd,df->bsf', x, w1)
        zero = torch.zeros_like(h)
        h = torch.maximum(h, zero)
        return torch.einsum('bsf,fd->bsd', h, w2)
    x = A_x
    mod = (_silu(c) @ w_mod).reshape(c.shape[0], 6, 1, -1)
    sa, ca, ga, sb, cb, gb = (mod[:, 0].clone(), mod[:, 1].clone(), mod[:, 2].clone(), mod[:, 3].clone(), mod[:, 4].clone(), mod[:, 5].clone())
    h = _layernorm(x, axis=-1) * (1 + ca) + sa
    x = x + ga * _A_ref(h, A_k_cache, A_v_cache, A_wq, A_wo)
    h = _layernorm(x, axis=-1) * (1 + cb) + sb
    x = x + gb * _B_ref(h, B_w1, B_w2)
    return x
```

```asm
; @launch grid=(256,1,1) block=(768,1,1) lds=155648
.amdgcn_target "amdgcn-amd-amdhsa--gfx950"
.text
.globl adaLN_cond__gqa_block_cached__dense_activation_relu__decode_kernel
.p2align 8
.type adaLN_cond__gqa_block_cached__dense_activation_relu__decode_kernel,@function
adaLN_cond__gqa_block_cached__dense_activation_relu__decode_kernel:
    s_cmp_ge_u32 s2, 256
    s_cbranch_scc1 L_exit
    s_load_dwordx16 s[8:23], s[0:1], 0
    s_load_dwordx8 s[24:31], s[0:1], 64
    s_load_dwordx2 s[32:33], s[0:1], 96
    v_lshrrev_b32 v1, 6, v0
    v_and_b32 v0, 63, v0
    v_readfirstlane_b32 s3, v1
    s_cmp_ge_u32 s3, 8
    s_cbranch_scc1 L_ctl
    s_lshl_b32 s52, s2, 3
    s_add_u32 s52, s52, s3
    s_lshl_b32 s52, s52, 15
    v_lshlrev_b32 v1, 4, v0
    s_lshl_b32 s54, s3, 2
    s_add_u32 s54, s54, s2
    s_and_b32 s54, s54, 31
    s_lshl_b32 s54, s54, 10
    s_waitcnt lgkmcnt(0)
    s_add_u32 s44, s10, s52
    s_addc_u32 s45, s11, 0
    s_mov_b32 s46, 32768
    s_mov_b32 s47, 0x20000
    s_barrier
    buffer_load_dwordx4 v[40:43], v1, s[44:47], s54 offen nt
    s_add_u32 s54, s54, 1024
    s_and_b32 s54, s54, 0x7fff
    buffer_load_dwordx4 v[44:47], v1, s[44:47], s54 offen nt
    s_add_u32 s54, s54, 1024
    s_and_b32 s54, s54, 0x7fff
    buffer_load_dwordx4 v[48:51], v1, s[44:47], s54 offen nt
    s_add_u32 s54, s54, 1024
    s_and_b32 s54, s54, 0x7fff
    buffer_load_dwordx4 v[52:55], v1, s[44:47], s54 offen nt
    s_add_u32 s54, s54, 1024
    s_and_b32 s54, s54, 0x7fff
    s_load_dwordx2 s[34:35], s[32:33], 0
    s_add_u32 s48, s12, s52
    s_addc_u32 s49, s13, 0
    s_mov_b32 s50, 32768
    s_mov_b32 s51, 0x20000
    s_mov_b32 s40, s32
    s_mov_b32 s41, s33
    s_mov_b32 s42, 1048576
    s_mov_b32 s43, 0x20000
    s_mov_b32 s74, 0xffff0000
    s_mov_b32 s38, 0x40000
    s_mov_b32 s64, 0xcccccccc
    s_mov_b32 s65, 0xcccccccc
    s_mov_b32 s66, 0xaaaaaaaa
    s_mov_b32 s67, 0xaaaaaaaa
    s_mov_b32 s68, 0xffff0000
    s_mov_b32 s69, 0
    s_mov_b32 s70, 0
    s_mov_b32 s71, 0xffff
    s_mov_b32 s72, 0
    s_mov_b32 s73, 0xffff0000
    s_mul_i32 s57, s3, 12288
    s_add_u32 s57, s57, 57344
    s_mov_b32 m0, s57
    v_add_u32 v3, s57, v1
    s_waitcnt vmcnt(3)
    buffer_load_dwordx4 v[56:59], v1, s[44:47], s54 offen nt
    s_add_u32 s54, s54, 1024
    s_and_b32 s54, s54, 0x7fff
    s_waitcnt vmcnt(3)
    buffer_load_dwordx4 v[60:63], v1, s[44:47], s54 offen nt
    s_add_u32 s54, s54, 1024
    s_and_b32 s54, s54, 0x7fff
    s_waitcnt lgkmcnt(0)
    s_add_u32 s34, s34, 1
    s_addc_u32 s35, s35, 0
    s_xor_b32 s36, s34, 0x5bd1e995
    s_xor_b32 s37, s35, 0x9e3779b9
    s_waitcnt vmcnt(3)
    buffer_load_dwordx4 v[64:67], v1, s[44:47], s54 offen nt
    s_add_u32 s54, s54, 1024
    s_and_b32 s54, s54, 0x7fff
    s_waitcnt vmcnt(3)
    buffer_load_dwordx4 v[68:71], v1, s[44:47], s54 offen nt
    s_add_u32 s54, s54, 1024
    s_and_b32 s54, s54, 0x7fff
    s_waitcnt vmcnt(3)
    buffer_load_dwordx4 v[72:75], v1, s[44:47], s54 offen nt
    s_add_u32 s54, s54, 1024
    s_and_b32 s54, s54, 0x7fff
    s_waitcnt vmcnt(3)
    buffer_load_dwordx4 v[76:79], v1, s[44:47], s54 offen nt
    s_add_u32 s54, s54, 1024
    s_and_b32 s54, s54, 0x7fff
    s_waitcnt vmcnt(3)
    buffer_load_dwordx4 v[80:83], v1, s[44:47], s54 offen nt
    s_add_u32 s54, s54, 1024
    s_and_b32 s54, s54, 0x7fff
    s_waitcnt vmcnt(3)
    buffer_load_dwordx4 v[84:87], v1, s[44:47], s54 offen nt
    s_add_u32 s54, s54, 1024
    s_and_b32 s54, s54, 0x7fff
    s_waitcnt vmcnt(3)
    buffer_load_dwordx4 v[88:91], v1, s[44:47], s54 offen nt
    s_add_u32 s54, s54, 1024
    s_and_b32 s54, s54, 0x7fff
    s_waitcnt vmcnt(3)
    buffer_load_dwordx4 v[92:95], v1, s[44:47], s54 offen nt
    s_add_u32 s54, s54, 1024
    s_and_b32 s54, s54, 0x7fff
    s_waitcnt vmcnt(3)
    buffer_load_dwordx4 v[96:99], v1, s[44:47], s54 offen nt
    s_add_u32 s54, s54, 1024
    s_and_b32 s54, s54, 0x7fff
    s_waitcnt vmcnt(3)
    buffer_load_dwordx4 v[100:103], v1, s[44:47], s54 offen nt
    s_add_u32 s54, s54, 1024
    s_and_b32 s54, s54, 0x7fff
    s_waitcnt vmcnt(3)
    buffer_load_dwordx4 v[104:107], v1, s[44:47], s54 offen nt
    s_add_u32 s54, s54, 1024
    s_and_b32 s54, s54, 0x7fff
    s_waitcnt vmcnt(3)
    buffer_load_dwordx4 v[108:111], v1, s[44:47], s54 offen nt
    s_add_u32 s54, s54, 1024
    s_and_b32 s54, s54, 0x7fff
    s_waitcnt vmcnt(3)
    buffer_load_dwordx4 v[112:115], v1, s[44:47], s54 offen nt
    s_add_u32 s54, s54, 1024
    s_and_b32 s54, s54, 0x7fff
    s_waitcnt vmcnt(3)
    buffer_load_dwordx4 v[116:119], v1, s[44:47], s54 offen nt
    s_add_u32 s54, s54, 1024
    s_and_b32 s54, s54, 0x7fff
    s_waitcnt vmcnt(3)
    buffer_load_dwordx4 v[120:123], v1, s[44:47], s54 offen nt
    s_add_u32 s54, s54, 1024
    s_and_b32 s54, s54, 0x7fff
    s_waitcnt vmcnt(3)
    buffer_load_dwordx4 v[124:127], v1, s[44:47], s54 offen nt
    s_add_u32 s54, s54, 1024
    s_and_b32 s54, s54, 0x7fff
    s_waitcnt vmcnt(3)
    buffer_load_dwordx4 v[128:131], v1, s[44:47], s54 offen nt
    s_add_u32 s54, s54, 1024
    s_and_b32 s54, s54, 0x7fff
    s_waitcnt vmcnt(3)
    buffer_load_dwordx4 v[132:135], v1, s[44:47], s54 offen nt
    s_add_u32 s54, s54, 1024
    s_and_b32 s54, s54, 0x7fff
    s_waitcnt vmcnt(3)
    buffer_load_dwordx4 v[136:139], v1, s[44:47], s54 offen nt
    s_add_u32 s54, s54, 1024
    s_and_b32 s54, s54, 0x7fff
    s_waitcnt vmcnt(3)
    buffer_load_dwordx4 v[140:143], v1, s[44:47], s54 offen nt
    s_add_u32 s54, s54, 1024
    s_and_b32 s54, s54, 0x7fff
    s_waitcnt vmcnt(3)
    buffer_load_dwordx4 v[144:147], v1, s[44:47], s54 offen nt
    s_add_u32 s54, s54, 1024
    s_and_b32 s54, s54, 0x7fff
    s_waitcnt vmcnt(3)
    buffer_load_dwordx4 v[148:151], v1, s[44:47], s54 offen nt
    s_add_u32 s54, s54, 1024
    s_and_b32 s54, s54, 0x7fff
    s_waitcnt vmcnt(3)
    buffer_load_dwordx4 v[152:155], v1, s[44:47], s54 offen nt
    s_add_u32 s54, s54, 1024
    s_and_b32 s54, s54, 0x7fff
    s_waitcnt vmcnt(3)
    buffer_load_dwordx4 v[156:159], v1, s[44:47], s54 offen nt
    s_add_u32 s54, s54, 1024
    s_and_b32 s54, s54, 0x7fff
    s_waitcnt vmcnt(3)
    buffer_load_dwordx4 v[160:163], v1, s[44:47], s54 offen nt
    s_add_u32 s54, s54, 1024
    s_and_b32 s54, s54, 0x7fff
    s_waitcnt vmcnt(3)
    buffer_load_dwordx4 v[164:167], v1, s[44:47], s54 offen nt
    s_add_u32 s54, s54, 1024
    s_and_b32 s54, s54, 0x7fff
    s_waitcnt vmcnt(3)
    buffer_load_dwordx4 v1, s[48:51], s54 offen nt lds
    s_add_u32 s54, s54, 1024
    s_and_b32 s54, s54, 0x7fff
    s_add_u32 m0, m0, 1024
    s_waitcnt vmcnt(3)
    buffer_load_dwordx4 v1, s[48:51], s54 offen nt lds
    s_add_u32 s54, s54, 1024
    s_and_b32 s54, s54, 0x7fff
    s_add_u32 m0, m0, 1024
    s_waitcnt vmcnt(3)
    buffer_load_dwordx4 v1, s[48:51], s54 offen nt lds
    s_add_u32 s54, s54, 1024
    s_and_b32 s54, s54, 0x7fff
    s_add_u32 m0, m0, 1024
    s_waitcnt vmcnt(3)
    buffer_load_dwordx4 v1, s[48:51], s54 offen nt lds
    s_add_u32 s54, s54, 1024
    s_and_b32 s54, s54, 0x7fff
    s_add_u32 m0, m0, 1024
    s_waitcnt vmcnt(3)
    buffer_load_dwordx4 v1, s[48:51], s54 offen nt lds
    s_add_u32 s54, s54, 1024
    s_and_b32 s54, s54, 0x7fff
    s_add_u32 m0, m0, 1024
    s_waitcnt vmcnt(3)
    buffer_load_dwordx4 v1, s[48:51], s54 offen nt lds
    s_add_u32 s54, s54, 1024
    s_and_b32 s54, s54, 0x7fff
    s_add_u32 m0, m0, 1024
    s_waitcnt vmcnt(3)
    buffer_load_dwordx4 v1, s[48:51], s54 offen nt lds
    s_add_u32 s54, s54, 1024
    s_and_b32 s54, s54, 0x7fff
    s_add_u32 m0, m0, 1024
    s_waitcnt vmcnt(3)
    buffer_load_dwordx4 v1, s[48:51], s54 offen nt lds
    s_add_u32 s54, s54, 1024
    s_and_b32 s54, s54, 0x7fff
    s_add_u32 m0, m0, 1024
    s_waitcnt vmcnt(3)
    buffer_load_dwordx4 v1, s[48:51], s54 offen nt lds
    s_add_u32 s54, s54, 1024
    s_and_b32 s54, s54, 0x7fff
    s_add_u32 m0, m0, 1024
    s_waitcnt vmcnt(3)
    buffer_load_dwordx4 v1, s[48:51], s54 offen nt lds
    s_add_u32 s54, s54, 1024
    s_and_b32 s54, s54, 0x7fff
    s_add_u32 m0, m0, 1024
    s_waitcnt vmcnt(3)
    buffer_load_dwordx4 v1, s[48:51], s54 offen nt lds
    s_add_u32 s54, s54, 1024
    s_and_b32 s54, s54, 0x7fff
    s_add_u32 m0, m0, 1024
    s_waitcnt vmcnt(3)
    buffer_load_dwordx4 v1, s[48:51], s54 offen nt lds
    s_add_u32 s54, s54, 1024
    s_and_b32 s54, s54, 0x7fff
    v_and_b32 v2, 15, v0
    v_lshlrev_b32 v2, 4, v2
    s_barrier
    ds_read_b128 v[4:7], v2 offset:0
    s_waitcnt lgkmcnt(0)
    s_cmp_ge_u32 s3, 4
    s_cbranch_scc0 L_pr_1
    s_setprio 1
L_pr_1:
    v_dot2_f32_bf16 v10, v40, v4, 0
    v_dot2_f32_bf16 v11, v44, v4, 0
    v_dot2_f32_bf16 v12, v48, v4, 0
    v_dot2_f32_bf16 v13, v52, v4, 0
    v_dot2_f32_bf16 v10, v41, v5, v10
    v_dot2_f32_bf16 v11, v45, v5, v11
    v_dot2_f32_bf16 v12, v49, v5, v12
    v_dot2_f32_bf16 v13, v53, v5, v13
    v_dot2_f32_bf16 v10, v42, v6, v10
    v_dot2_f32_bf16 v11, v46, v6, v11
    v_dot2_f32_bf16 v12, v50, v6, v12
    v_dot2_f32_bf16 v13, v54, v6, v13
    v_dot2_f32_bf16 v10, v43, v7, v10
    v_dot2_f32_bf16 v11, v47, v7, v11
    v_dot2_f32_bf16 v12, v51, v7, v12
    v_dot2_f32_bf16 v13, v55, v7, v13
    v_add_f32_dpp v14, v10, v10 row_ror:8 row_mask:0xf bank_mask:0x3
    s_nop 0
    v_add_f32_dpp v15, v12, v12 row_ror:8 row_mask:0xf bank_mask:0x3
    v_add_f32_dpp v14, v11, v11 row_ror:8 row_mask:0xf bank_mask:0xc
    s_nop 0
    v_add_f32_dpp v15, v13, v13 row_ror:8 row_mask:0xf bank_mask:0xc
    v_add_f32_dpp v16, v14, v14 row_half_mirror row_mask:0xf bank_mask:0x5
    s_nop 1
    v_add_f32_dpp v16, v15, v15 row_half_mirror row_mask:0xf bank_mask:0xa
    v_dot2_f32_bf16 v10, v56, v4, 0
    v_dot2_f32_bf16 v11, v60, v4, 0
    v_dot2_f32_bf16 v12, v64, v4, 0
    v_dot2_f32_bf16 v13, v68, v4, 0
    v_dot2_f32_bf16 v10, v57, v5, v10
    v_dot2_f32_bf16 v11, v61, v5, v11
    v_dot2_f32_bf16 v12, v65, v5, v12
    v_dot2_f32_bf16 v13, v69, v5, v13
    v_dot2_f32_bf16 v10, v58, v6, v10
    v_dot2_f32_bf16 v11, v62, v6, v11
    v_dot2_f32_bf16 v12, v66, v6, v12
    v_dot2_f32_bf16 v13, v70, v6, v13
    v_dot2_f32_bf16 v10, v59, v7, v10
    v_dot2_f32_bf16 v11, v63, v7, v11
    v_dot2_f32_bf16 v12, v67, v7, v12
    v_dot2_f32_bf16 v13, v71, v7, v13
    v_add_f32_dpp v14, v10, v10 row_ror:8 row_mask:0xf bank_mask:0x3
    s_nop 0
    v_add_f32_dpp v15, v12, v12 row_ror:8 row_mask:0xf bank_mask:0x3
    v_add_f32_dpp v14, v11, v11 row_ror:8 row_mask:0xf bank_mask:0xc
    s_nop 0
    v_add_f32_dpp v15, v13, v13 row_ror:8 row_mask:0xf bank_mask:0xc
    v_add_f32_dpp v17, v14, v14 row_half_mirror row_mask:0xf bank_mask:0x5
    s_nop 1
    v_add_f32_dpp v17, v15, v15 row_half_mirror row_mask:0xf bank_mask:0xa
    v_dot2_f32_bf16 v10, v72, v4, 0
    v_dot2_f32_bf16 v11, v76, v4, 0
    v_dot2_f32_bf16 v12, v80, v4, 0
    v_dot2_f32_bf16 v13, v84, v4, 0
    v_dot2_f32_bf16 v10, v73, v5, v10
    v_dot2_f32_bf16 v11, v77, v5, v11
    v_dot2_f32_bf16 v12, v81, v5, v12
    v_dot2_f32_bf16 v13, v85, v5, v13
    v_dot2_f32_bf16 v10, v74, v6, v10
    v_dot2_f32_bf16 v11, v78, v6, v11
    v_dot2_f32_bf16 v12, v82, v6, v12
    v_dot2_f32_bf16 v13, v86, v6, v13
    v_dot2_f32_bf16 v10, v75, v7, v10
    v_dot2_f32_bf16 v11, v79, v7, v11
    v_dot2_f32_bf16 v12, v83, v7, v12
    v_dot2_f32_bf16 v13, v87, v7, v13
    v_add_f32_dpp v14, v10, v10 row_ror:8 row_mask:0xf bank_mask:0x3
    s_nop 0
    v_add_f32_dpp v15, v12, v12 row_ror:8 row_mask:0xf bank_mask:0x3
    v_add_f32_dpp v14, v11, v11 row_ror:8 row_mask:0xf bank_mask:0xc
    s_nop 0
    v_add_f32_dpp v15, v13, v13 row_ror:8 row_mask:0xf bank_mask:0xc
    v_add_f32_dpp v18, v14, v14 row_half_mirror row_mask:0xf bank_mask:0x5
    s_nop 1
    v_add_f32_dpp v18, v15, v15 row_half_mirror row_mask:0xf bank_mask:0xa
    s_waitcnt vmcnt(3)
    buffer_load_dwordx4 v[40:43], v1, s[48:51], s54 offen nt
    s_add_u32 s54, s54, 1024
    s_and_b32 s54, s54, 0x7fff
    v_dot2_f32_bf16 v10, v88, v4, 0
    v_dot2_f32_bf16 v11, v92, v4, 0
    v_dot2_f32_bf16 v12, v96, v4, 0
    v_dot2_f32_bf16 v13, v100, v4, 0
    v_dot2_f32_bf16 v10, v89, v5, v10
    v_dot2_f32_bf16 v11, v93, v5, v11
    v_dot2_f32_bf16 v12, v97, v5, v12
    v_dot2_f32_bf16 v13, v101, v5, v13
    v_dot2_f32_bf16 v10, v90, v6, v10
    v_dot2_f32_bf16 v11, v94, v6, v11
    v_dot2_f32_bf16 v12, v98, v6, v12
    v_dot2_f32_bf16 v13, v102, v6, v13
    v_dot2_f32_bf16 v10, v91, v7, v10
    v_dot2_f32_bf16 v11, v95, v7, v11
    v_dot2_f32_bf16 v12, v99, v7, v12
    v_dot2_f32_bf16 v13, v103, v7, v13
    v_add_f32_dpp v14, v10, v10 row_ror:8 row_mask:0xf bank_mask:0x3
    s_nop 0
    v_add_f32_dpp v15, v12, v12 row_ror:8 row_mask:0xf bank_mask:0x3
    v_add_f32_dpp v14, v11, v11 row_ror:8 row_mask:0xf bank_mask:0xc
    s_nop 0
    v_add_f32_dpp v15, v13, v13 row_ror:8 row_mask:0xf bank_mask:0xc
    v_add_f32_dpp v19, v14, v14 row_half_mirror row_mask:0xf bank_mask:0x5
    s_nop 1
    v_add_f32_dpp v19, v15, v15 row_half_mirror row_mask:0xf bank_mask:0xa
    v_add_f32_dpp v20, v16, v16 quad_perm:[2,3,0,1] row_mask:0xf bank_mask:0xf
    v_add_f32_dpp v21, v17, v17 quad_perm:[2,3,0,1] row_mask:0xf bank_mask:0xf
    v_cndmask_b32 v16, v20, v21, s[64:65]
    v_add_f32_dpp v20, v18, v18 quad_perm:[2,3,0,1] row_mask:0xf bank_mask:0xf
    v_add_f32_dpp v21, v19, v19 quad_perm:[2,3,0,1] row_mask:0xf bank_mask:0xf
    v_cndmask_b32 v18, v20, v21, s[64:65]
    v_add_f32_dpp v20, v16, v16 quad_perm:[1,0,3,2] row_mask:0xf bank_mask:0xf
    s_nop 0
    v_add_f32_dpp v21, v18, v18 quad_perm:[1,0,3,2] row_mask:0xf bank_mask:0xf
    v_cndmask_b32 v8, v20, v21, s[66:67]
    v_dot2_f32_bf16 v10, v104, v4, 0
    v_dot2_f32_bf16 v11, v108, v4, 0
    v_dot2_f32_bf16 v12, v112, v4, 0
    v_dot2_f32_bf16 v13, v116, v4, 0
    v_dot2_f32_bf16 v10, v105, v5, v10
    v_dot2_f32_bf16 v11, v109, v5, v11
    v_dot2_f32_bf16 v12, v113, v5, v12
    v_dot2_f32_bf16 v13, v117, v5, v13
    v_dot2_f32_bf16 v10, v106, v6, v10
    v_dot2_f32_bf16 v11, v110, v6, v11
    v_dot2_f32_bf16 v12, v114, v6, v12
    v_dot2_f32_bf16 v13, v118, v6, v13
    v_dot2_f32_bf16 v10, v107, v7, v10
    v_dot2_f32_bf16 v11, v111, v7, v11
    v_dot2_f32_bf16 v12, v115, v7, v12
    v_dot2_f32_bf16 v13, v119, v7, v13
    v_add_f32_dpp v14, v10, v10 row_ror:8 row_mask:0xf bank_mask:0x3
    s_nop 0
    v_add_f32_dpp v15, v12, v12 row_ror:8 row_mask:0xf bank_mask:0x3
    v_add_f32_dpp v14, v11, v11 row_ror:8 row_mask:0xf bank_mask:0xc
    s_nop 0
    v_add_f32_dpp v15, v13, v13 row_ror:8 row_mask:0xf bank_mask:0xc
    v_add_f32_dpp v16, v14, v14 row_half_mirror row_mask:0xf bank_mask:0x5
    s_nop 1
    v_add_f32_dpp v16, v15, v15 row_half_mirror row_mask:0xf bank_mask:0xa
    v_dot2_f32_bf16 v10, v120, v4, 0
    v_dot2_f32_bf16 v11, v124, v4, 0
    v_dot2_f32_bf16 v12, v128, v4, 0
    v_dot2_f32_bf16 v13, v132, v4, 0
    v_dot2_f32_bf16 v10, v121, v5, v10
    v_dot2_f32_bf16 v11, v125, v5, v11
    v_dot2_f32_bf16 v12, v129, v5, v12
    v_dot2_f32_bf16 v13, v133, v5, v13
    v_dot2_f32_bf16 v10, v122, v6, v10
    v_dot2_f32_bf16 v11, v126, v6, v11
    v_dot2_f32_bf16 v12, v130, v6, v12
    v_dot2_f32_bf16 v13, v134, v6, v13
    v_dot2_f32_bf16 v10, v123, v7, v10
    v_dot2_f32_bf16 v11, v127, v7, v11
    v_dot2_f32_bf16 v12, v131, v7, v12
    v_dot2_f32_bf16 v13, v135, v7, v13
    v_add_f32_dpp v14, v10, v10 row_ror:8 row_mask:0xf bank_mask:0x3
    s_nop 0
    v_add_f32_dpp v15, v12, v12 row_ror:8 row_mask:0xf bank_mask:0x3
    v_add_f32_dpp v14, v11, v11 row_ror:8 row_mask:0xf bank_mask:0xc
    s_nop 0
    v_add_f32_dpp v15, v13, v13 row_ror:8 row_mask:0xf bank_mask:0xc
    v_add_f32_dpp v17, v14, v14 row_half_mirror row_mask:0xf bank_mask:0x5
    s_nop 1
    v_add_f32_dpp v17, v15, v15 row_half_mirror row_mask:0xf bank_mask:0xa
    s_waitcnt vmcnt(3)
    buffer_load_dwordx4 v[44:47], v1, s[48:51], s54 offen nt
    s_add_u32 s54, s54, 1024
    s_and_b32 s54, s54, 0x7fff
    v_dot2_f32_bf16 v10, v136, v4, 0
    v_dot2_f32_bf16 v11, v140, v4, 0
    v_dot2_f32_bf16 v12, v144, v4, 0
    v_dot2_f32_bf16 v13, v148, v4, 0
    v_dot2_f32_bf16 v10, v137, v5, v10
    v_dot2_f32_bf16 v11, v141, v5, v11
    v_dot2_f32_bf16 v12, v145, v5, v12
    v_dot2_f32_bf16 v13, v149, v5, v13
    v_dot2_f32_bf16 v10, v138, v6, v10
    v_dot2_f32_bf16 v11, v142, v6, v11
    v_dot2_f32_bf16 v12, v146, v6, v12
    v_dot2_f32_bf16 v13, v150, v6, v13
    v_dot2_f32_bf16 v10, v139, v7, v10
    v_dot2_f32_bf16 v11, v143, v7, v11
    v_dot2_f32_bf16 v12, v147, v7, v12
    v_dot2_f32_bf16 v13, v151, v7, v13
    v_add_f32_dpp v14, v10, v10 row_ror:8 row_mask:0xf bank_mask:0x3
    s_nop 0
    v_add_f32_dpp v15, v12, v12 row_ror:8 row_mask:0xf bank_mask:0x3
    v_add_f32_dpp v14, v11, v11 row_ror:8 row_mask:0xf bank_mask:0xc
    s_nop 0
    v_add_f32_dpp v15, v13, v13 row_ror:8 row_mask:0xf bank_mask:0xc
    v_add_f32_dpp v18, v14, v14 row_half_mirror row_mask:0xf bank_mask:0x5
    s_nop 1
    v_add_f32_dpp v18, v15, v15 row_half_mirror row_mask:0xf bank_mask:0xa
    v_dot2_f32_bf16 v10, v152, v4, 0
    v_dot2_f32_bf16 v11, v156, v4, 0
    v_dot2_f32_bf16 v12, v160, v4, 0
    v_dot2_f32_bf16 v13, v164, v4, 0
    v_dot2_f32_bf16 v10, v153, v5, v10
    v_dot2_f32_bf16 v11, v157, v5, v11
    v_dot2_f32_bf16 v12, v161, v5, v12
    v_dot2_f32_bf16 v13, v165, v5, v13
    v_dot2_f32_bf16 v10, v154, v6, v10
    v_dot2_f32_bf16 v11, v158, v6, v11
    v_dot2_f32_bf16 v12, v162, v6, v12
    v_dot2_f32_bf16 v13, v166, v6, v13
    v_dot2_f32_bf16 v10, v155, v7, v10
    v_dot2_f32_bf16 v11, v159, v7, v11
    v_dot2_f32_bf16 v12, v163, v7, v12
    v_dot2_f32_bf16 v13, v167, v7, v13
    v_add_f32_dpp v14, v10, v10 row_ror:8 row_mask:0xf bank_mask:0x3
    s_nop 0
    v_add_f32_dpp v15, v12, v12 row_ror:8 row_mask:0xf bank_mask:0x3
    v_add_f32_dpp v14, v11, v11 row_ror:8 row_mask:0xf bank_mask:0xc
    s_nop 0
    v_add_f32_dpp v15, v13, v13 row_ror:8 row_mask:0xf bank_mask:0xc
    v_add_f32_dpp v19, v14, v14 row_half_mirror row_mask:0xf bank_mask:0x5
    s_nop 1
    v_add_f32_dpp v19, v15, v15 row_half_mirror row_mask:0xf bank_mask:0xa
    v_add_f32_dpp v20, v16, v16 quad_perm:[2,3,0,1] row_mask:0xf bank_mask:0xf
    v_add_f32_dpp v21, v17, v17 quad_perm:[2,3,0,1] row_mask:0xf bank_mask:0xf
    v_cndmask_b32 v16, v20, v21, s[64:65]
    v_add_f32_dpp v20, v18, v18 quad_perm:[2,3,0,1] row_mask:0xf bank_mask:0xf
    v_add_f32_dpp v21, v19, v19 quad_perm:[2,3,0,1] row_mask:0xf bank_mask:0xf
    v_cndmask_b32 v18, v20, v21, s[64:65]
    v_add_f32_dpp v20, v16, v16 quad_perm:[1,0,3,2] row_mask:0xf bank_mask:0xf
    s_nop 0
    v_add_f32_dpp v21, v18, v18 quad_perm:[1,0,3,2] row_mask:0xf bank_mask:0xf
    v_cndmask_b32 v9, v20, v21, s[66:67]
    s_setprio 0
    v_cvt_pk_bf16_f32 v10, v8, v9
    v_lshlrev_b32 v8, 16, v10
    v_and_b32 v9, s74, v10
    v_mul_f32 v8, 0x3db504f3, v8
    v_mul_f32 v9, 0x3db504f3, v9
    v_cvt_pk_bf16_f32 v10, v8, v9
    v_lshlrev_b32 v8, 16, v10
    v_and_b32 v9, s74, v10
    v_max_f32 v10, v8, v9
    s_nop 1
    v_max_f32_dpp v10, v10, v10 row_ror:8 row_mask:0xf bank_mask:0xf
    s_nop 1
    v_max_f32_dpp v10, v10, v10 row_ror:4 row_mask:0xf bank_mask:0xf
    s_nop 1
    v_max_f32_dpp v10, v10, v10 row_ror:2 row_mask:0xf bank_mask:0xf
    s_nop 1
    v_max_f32_dpp v10, v10, v10 row_ror:1 row_mask:0xf bank_mask:0xf
    s_nop 1
    v_max_f32_dpp v10, v10, v10 row_bcast:15 row_mask:0xa bank_mask:0xf
    s_nop 1
    v_max_f32_dpp v10, v10, v10 row_bcast:31 row_mask:0xc bank_mask:0xf
    s_nop 0
    v_readlane_b32 s55, v10, 63
    s_nop 1
    v_subrev_f32 v8, s55, v8
    v_subrev_f32 v9, s55, v9
    v_mul_f32 v8, 0x3fb8aa3b, v8
    v_mul_f32 v9, 0x3fb8aa3b, v9
    v_exp_f32 v8, v8
    v_exp_f32 v9, v9
    v_mov_b32 v11, s55
    s_lshl_b32 s56, s3, 2
    v_mov_b32 v12, s56
    s_mov_b64 exec, 1
    ds_write_b32 v12, v11 offset:256
    s_mov_b64 exec, -1
    v_add_f32 v10, v8, v9
    s_nop 1
    v_add_f32_dpp v10, v10, v10 row_ror:8 row_mask:0xf bank_mask:0xf
    s_nop 1
    v_add_f32_dpp v10, v10, v10 row_ror:4 row_mask:0xf bank_mask:0xf
    s_nop 1
    v_add_f32_dpp v10, v10, v10 row_ror:2 row_mask:0xf bank_mask:0xf
    s_nop 1
    v_add_f32_dpp v10, v10, v10 row_ror:1 row_mask:0xf bank_mask:0xf
    s_nop 1
    v_add_f32_dpp v10, v10, v10 row_bcast:15 row_mask:0xa bank_mask:0xf
    s_nop 1
    v_add_f32_dpp v10, v10, v10 row_bcast:31 row_mask:0xc bank_mask:0xf
    s_nop 0
    v_readlane_b32 s56, v10, 63
    v_mov_b32 v10, 0
    v_mov_b32 v11, 0
    v_mov_b32 v12, 0
    v_mov_b32 v13, 0
    v_mov_b32 v14, 0
    v_mov_b32 v15, 0
    v_mov_b32 v16, 0
    v_mov_b32 v17, 0
    s_waitcnt vmcnt(3)
    buffer_load_dwordx4 v[48:51], v1, s[48:51], s54 offen nt
    s_add_u32 s54, s54, 1024
    s_and_b32 s54, s54, 0x7fff
    ds_read_b128 v[28:31], v3 offset:0
    s_waitcnt lgkmcnt(0)
    ds_read_b128 v[32:35], v3 offset:1024
    v_mov_b32_dpp v26, v8 row_newbcast:0 row_mask:0xf bank_mask:0xf
    v_lshlrev_b32 v18, 16, v28
    v_and_b32 v19, s74, v28
    v_lshlrev_b32 v20, 16, v29
    v_and_b32 v21, s74, v29
    v_lshlrev_b32 v22, 16, v30
    v_and_b32 v23, s74, v30
    v_lshlrev_b32 v24, 16, v31
    v_and_b32 v25, s74, v31
    v_fmac_f32 v10, v26, v18
    v_fmac_f32 v11, v26, v19
    v_fmac_f32 v12, v26, v20
    v_fmac_f32 v13, v26, v21
    v_fmac_f32 v14, v26, v22
    v_fmac_f32 v15, v26, v23
    v_fmac_f32 v16, v26, v24
    v_fmac_f32 v17, v26, v25
    s_waitcnt lgkmcnt(0)
    ds_read_b128 v[28:31], v3 offset:2048
    v_mov_b32_dpp v26, v8 row_newbcast:8 row_mask:0xf bank_mask:0xf
    v_lshlrev_b32 v18, 16, v32
    v_and_b32 v19, s74, v32
    v_lshlrev_b32 v20, 16, v33
    v_and_b32 v21, s74, v33
    v_lshlrev_b32 v22, 16, v34
    v_and_b32 v23, s74, v34
    v_lshlrev_b32 v24, 16, v35
    v_and_b32 v25, s74, v35
    v_fmac_f32 v10, v26, v18
    v_fmac_f32 v11, v26, v19
    v_fmac_f32 v12, v26, v20
    v_fmac_f32 v13, v26, v21
    v_fmac_f32 v14, v26, v22
    v_fmac_f32 v15, v26, v23
    v_fmac_f32 v16, v26, v24
    v_fmac_f32 v17, v26, v25
    s_waitcnt lgkmcnt(0)
    ds_read_b128 v[32:35], v3 offset:3072
    v_mov_b32_dpp v26, v8 row_newbcast:4 row_mask:0xf bank_mask:0xf
    v_lshlrev_b32 v18, 16, v28
    v_and_b32 v19, s74, v28
    v_lshlrev_b32 v20, 16, v29
    v_and_b32 v21, s74, v29
    v_lshlrev_b32 v22, 16, v30
    v_and_b32 v23, s74, v30
    v_lshlrev_b32 v24, 16, v31
    v_and_b32 v25, s74, v31
    v_fmac_f32 v10, v26, v18
    v_fmac_f32 v11, v26, v19
    v_fmac_f32 v12, v26, v20
    v_fmac_f32 v13, v26, v21
    v_fmac_f32 v14, v26, v22
    v_fmac_f32 v15, v26, v23
    v_fmac_f32 v16, v26, v24
    v_fmac_f32 v17, v26, v25
    s_waitcnt lgkmcnt(0)
    ds_read_b128 v[28:31], v3 offset:4096
    v_mov_b32_dpp v26, v8 row_newbcast:12 row_mask:0xf bank_mask:0xf
    v_lshlrev_b32 v18, 16, v32
    v_and_b32 v19, s74, v32
    v_lshlrev_b32 v20, 16, v33
    v_and_b32 v21, s74, v33
    v_lshlrev_b32 v22, 16, v34
    v_and_b32 v23, s74, v34
    v_lshlrev_b32 v24, 16, v35
    v_and_b32 v25, s74, v35
    v_fmac_f32 v10, v26, v18
    v_fmac_f32 v11, v26, v19
    v_fmac_f32 v12, v26, v20
    v_fmac_f32 v13, v26, v21
    v_fmac_f32 v14, v26, v22
    v_fmac_f32 v15, v26, v23
    v_fmac_f32 v16, v26, v24
    v_fmac_f32 v17, v26, v25
    s_waitcnt vmcnt(3)
    buffer_load_dwordx4 v[52:55], v1, s[48:51], s54 offen nt
    s_add_u32 s54, s54, 1024
    s_and_b32 s54, s54, 0x7fff
    s_waitcnt lgkmcnt(0)
    ds_read_b128 v[32:35], v3 offset:5120
    v_mov_b32_dpp v26, v8 row_newbcast:2 row_mask:0xf bank_mask:0xf
    v_lshlrev_b32 v18, 16, v28
    v_and_b32 v19, s74, v28
    v_lshlrev_b32 v20, 16, v29
    v_and_b32 v21, s74, v29
    v_lshlrev_b32 v22, 16, v30
    v_and_b32 v23, s74, v30
    v_lshlrev_b32 v24, 16, v31
    v_and_b32 v25, s74, v31
    v_fmac_f32 v10, v26, v18
    v_fmac_f32 v11, v26, v19
    v_fmac_f32 v12, v26, v20
    v_fmac_f32 v13, v26, v21
    v_fmac_f32 v14, v26, v22
    v_fmac_f32 v15, v26, v23
    v_fmac_f32 v16, v26, v24
    v_fmac_f32 v17, v26, v25
    s_waitcnt lgkmcnt(0)
    ds_read_b128 v[28:31], v3 offset:6144
    v_mov_b32_dpp v26, v8 row_newbcast:10 row_mask:0xf bank_mask:0xf
    v_lshlrev_b32 v18, 16, v32
    v_and_b32 v19, s74, v32
    v_lshlrev_b32 v20, 16, v33
    v_and_b32 v21, s74, v33
    v_lshlrev_b32 v22, 16, v34
    v_and_b32 v23, s74, v34
    v_lshlrev_b32 v24, 16, v35
    v_and_b32 v25, s74, v35
    v_fmac_f32 v10, v26, v18
    v_fmac_f32 v11, v26, v19
    v_fmac_f32 v12, v26, v20
    v_fmac_f32 v13, v26, v21
    v_fmac_f32 v14, v26, v22
    v_fmac_f32 v15, v26, v23
    v_fmac_f32 v16, v26, v24
    v_fmac_f32 v17, v26, v25
    s_waitcnt lgkmcnt(0)
    ds_read_b128 v[32:35], v3 offset:7168
    v_mov_b32_dpp v26, v8 row_newbcast:6 row_mask:0xf bank_mask:0xf
    v_lshlrev_b32 v18, 16, v28
    v_and_b32 v19, s74, v28
    v_lshlrev_b32 v20, 16, v29
    v_and_b32 v21, s74, v29
    v_lshlrev_b32 v22, 16, v30
    v_and_b32 v23, s74, v30
    v_lshlrev_b32 v24, 16, v31
    v_and_b32 v25, s74, v31
    v_fmac_f32 v10, v26, v18
    v_fmac_f32 v11, v26, v19
    v_fmac_f32 v12, v26, v20
    v_fmac_f32 v13, v26, v21
    v_fmac_f32 v14, v26, v22
    v_fmac_f32 v15, v26, v23
    v_fmac_f32 v16, v26, v24
    v_fmac_f32 v17, v26, v25
    s_waitcnt lgkmcnt(0)
    ds_read_b128 v[28:31], v3 offset:8192
    v_mov_b32_dpp v26, v8 row_newbcast:14 row_mask:0xf bank_mask:0xf
    v_lshlrev_b32 v18, 16, v32
    v_and_b32 v19, s74, v32
    v_lshlrev_b32 v20, 16, v33
    v_and_b32 v21, s74, v33
    v_lshlrev_b32 v22, 16, v34
    v_and_b32 v23, s74, v34
    v_lshlrev_b32 v24, 16, v35
    v_and_b32 v25, s74, v35
    v_fmac_f32 v10, v26, v18
    v_fmac_f32 v11, v26, v19
    v_fmac_f32 v12, v26, v20
    v_fmac_f32 v13, v26, v21
    v_fmac_f32 v14, v26, v22
    v_fmac_f32 v15, v26, v23
    v_fmac_f32 v16, v26, v24
    v_fmac_f32 v17, v26, v25
    s_waitcnt vmcnt(3)
    buffer_load_dwordx4 v[56:59], v1, s[48:51], s54 offen nt
    s_add_u32 s54, s54, 1024
    s_and_b32 s54, s54, 0x7fff
    s_waitcnt lgkmcnt(0)
    ds_read_b128 v[32:35], v3 offset:9216
    v_mov_b32_dpp v26, v8 row_newbcast:1 row_mask:0xf bank_mask:0xf
    v_lshlrev_b32 v18, 16, v28
    v_and_b32 v19, s74, v28
    v_lshlrev_b32 v20, 16, v29
    v_and_b32 v21, s74, v29
    v_lshlrev_b32 v22, 16, v30
    v_and_b32 v23, s74, v30
    v_lshlrev_b32 v24, 16, v31
    v_and_b32 v25, s74, v31
    v_fmac_f32 v10, v26, v18
    v_fmac_f32 v11, v26, v19
    v_fmac_f32 v12, v26, v20
    v_fmac_f32 v13, v26, v21
    v_fmac_f32 v14, v26, v22
    v_fmac_f32 v15, v26, v23
    v_fmac_f32 v16, v26, v24
    v_fmac_f32 v17, v26, v25
    s_waitcnt lgkmcnt(0)
    ds_read_b128 v[28:31], v3 offset:10240
    v_mov_b32_dpp v26, v8 row_newbcast:9 row_mask:0xf bank_mask:0xf
    v_lshlrev_b32 v18, 16, v32
    v_and_b32 v19, s74, v32
    v_lshlrev_b32 v20, 16, v33
    v_and_b32 v21, s74, v33
    v_lshlrev_b32 v22, 16, v34
    v_and_b32 v23, s74, v34
    v_lshlrev_b32 v24, 16, v35
    v_and_b32 v25, s74, v35
    v_fmac_f32 v10, v26, v18
    v_fmac_f32 v11, v26, v19
    v_fmac_f32 v12, v26, v20
    v_fmac_f32 v13, v26, v21
    v_fmac_f32 v14, v26, v22
    v_fmac_f32 v15, v26, v23
    v_fmac_f32 v16, v26, v24
    v_fmac_f32 v17, v26, v25
    s_waitcnt lgkmcnt(0)
    ds_read_b128 v[32:35], v3 offset:11264
    v_mov_b32_dpp v26, v8 row_newbcast:5 row_mask:0xf bank_mask:0xf
    v_lshlrev_b32 v18, 16, v28
    v_and_b32 v19, s74, v28
    v_lshlrev_b32 v20, 16, v29
    v_and_b32 v21, s74, v29
    v_lshlrev_b32 v22, 16, v30
    v_and_b32 v23, s74, v30
    v_lshlrev_b32 v24, 16, v31
    v_and_b32 v25, s74, v31
    v_fmac_f32 v10, v26, v18
    v_fmac_f32 v11, v26, v19
    v_fmac_f32 v12, v26, v20
    v_fmac_f32 v13, v26, v21
    v_fmac_f32 v14, v26, v22
    v_fmac_f32 v15, v26, v23
    v_fmac_f32 v16, v26, v24
    v_fmac_f32 v17, v26, v25
    s_waitcnt lgkmcnt(0)
    v_mov_b32_dpp v26, v8 row_newbcast:13 row_mask:0xf bank_mask:0xf
    v_lshlrev_b32 v18, 16, v32
    v_and_b32 v19, s74, v32
    v_lshlrev_b32 v20, 16, v33
    v_and_b32 v21, s74, v33
    v_lshlrev_b32 v22, 16, v34
    v_and_b32 v23, s74, v34
    v_lshlrev_b32 v24, 16, v35
    v_and_b32 v25, s74, v35
    v_fmac_f32 v10, v26, v18
    v_fmac_f32 v11, v26, v19
    v_fmac_f32 v12, v26, v20
    v_fmac_f32 v13, v26, v21
    v_fmac_f32 v14, v26, v22
    v_fmac_f32 v15, v26, v23
    v_fmac_f32 v16, v26, v24
    v_fmac_f32 v17, v26, v25
    s_waitcnt vmcnt(3)
    buffer_load_dwordx4 v[60:63], v1, s[48:51], s54 offen nt
    s_add_u32 s54, s54, 1024
    s_and_b32 s54, s54, 0x7fff
    v_mov_b32_dpp v26, v8 row_newbcast:3 row_mask:0xf bank_mask:0xf
    v_lshlrev_b32 v18, 16, v40
    v_and_b32 v19, s74, v40
    v_lshlrev_b32 v20, 16, v41
    v_and_b32 v21, s74, v41
    v_lshlrev_b32 v22, 16, v42
    v_and_b32 v23, s74, v42
    v_lshlrev_b32 v24, 16, v43
    v_and_b32 v25, s74, v43
    v_fmac_f32 v10, v26, v18
    v_fmac_f32 v11, v26, v19
    v_fmac_f32 v12, v26, v20
    v_fmac_f32 v13, v26, v21
    v_fmac_f32 v14, v26, v22
    v_fmac_f32 v15, v26, v23
    v_fmac_f32 v16, v26, v24
    v_fmac_f32 v17, v26, v25
    v_mov_b32_dpp v26, v8 row_newbcast:11 row_mask:0xf bank_mask:0xf
    v_lshlrev_b32 v18, 16, v44
    v_and_b32 v19, s74, v44
    v_lshlrev_b32 v20, 16, v45
    v_and_b32 v21, s74, v45
    v_lshlrev_b32 v22, 16, v46
    v_and_b32 v23, s74, v46
    v_lshlrev_b32 v24, 16, v47
    v_and_b32 v25, s74, v47
    v_fmac_f32 v10, v26, v18
    v_fmac_f32 v11, v26, v19
    v_fmac_f32 v12, v26, v20
    v_fmac_f32 v13, v26, v21
    v_fmac_f32 v14, v26, v22
    v_fmac_f32 v15, v26, v23
    v_fmac_f32 v16, v26, v24
    v_fmac_f32 v17, v26, v25
    s_waitcnt vmcnt(3)
    buffer_load_dwordx4 v[64:67], v1, s[48:51], s54 offen nt
    s_add_u32 s54, s54, 1024
    s_and_b32 s54, s54, 0x7fff
    v_mov_b32_dpp v26, v8 row_newbcast:7 row_mask:0xf bank_mask:0xf
    v_lshlrev_b32 v18, 16, v48
    v_and_b32 v19, s74, v48
    v_lshlrev_b32 v20, 16, v49
    v_and_b32 v21, s74, v49
    v_lshlrev_b32 v22, 16, v50
    v_and_b32 v23, s74, v50
    v_lshlrev_b32 v24, 16, v51
    v_and_b32 v25, s74, v51
    v_fmac_f32 v10, v26, v18
    v_fmac_f32 v11, v26, v19
    v_fmac_f32 v12, v26, v20
    v_fmac_f32 v13, v26, v21
    v_fmac_f32 v14, v26, v22
    v_fmac_f32 v15, v26, v23
    v_fmac_f32 v16, v26, v24
    v_fmac_f32 v17, v26, v25
    s_waitcnt vmcnt(3)
    buffer_load_dwordx4 v[68:71], v1, s[48:51], s54 offen nt
    s_add_u32 s54, s54, 1024
    s_and_b32 s54, s54, 0x7fff
    v_mov_b32_dpp v26, v8 row_newbcast:15 row_mask:0xf bank_mask:0xf
    v_lshlrev_b32 v18, 16, v52
    v_and_b32 v19, s74, v52
    v_lshlrev_b32 v20, 16, v53
    v_and_b32 v21, s74, v53
    v_lshlrev_b32 v22, 16, v54
    v_and_b32 v23, s74, v54
    v_lshlrev_b32 v24, 16, v55
    v_and_b32 v25, s74, v55
    v_fmac_f32 v10, v26, v18
    v_fmac_f32 v11, v26, v19
    v_fmac_f32 v12, v26, v20
    v_fmac_f32 v13, v26, v21
    v_fmac_f32 v14, v26, v22
    v_fmac_f32 v15, v26, v23
    v_fmac_f32 v16, v26, v24
    v_fmac_f32 v17, v26, v25
    s_waitcnt vmcnt(3)
    buffer_load_dwordx4 v[72:75], v1, s[48:51], s54 offen nt
    s_add_u32 s54, s54, 1024
    s_and_b32 s54, s54, 0x7fff
    v_mov_b32_dpp v26, v9 row_newbcast:0 row_mask:0xf bank_mask:0xf
    v_lshlrev_b32 v18, 16, v56
    v_and_b32 v19, s74, v56
    v_lshlrev_b32 v20, 16, v57
    v_and_b32 v21, s74, v57
    v_lshlrev_b32 v22, 16, v58
    v_and_b32 v23, s74, v58
    v_lshlrev_b32 v24, 16, v59
    v_and_b32 v25, s74, v59
    v_fmac_f32 v10, v26, v18
    v_fmac_f32 v11, v26, v19
    v_fmac_f32 v12, v26, v20
    v_fmac_f32 v13, v26, v21
    v_fmac_f32 v14, v26, v22
    v_fmac_f32 v15, v26, v23
    v_fmac_f32 v16, v26, v24
    v_fmac_f32 v17, v26, v25
    s_waitcnt vmcnt(3)
    buffer_load_dwordx4 v[76:79], v1, s[48:51], s54 offen nt
    s_add_u32 s54, s54, 1024
    s_and_b32 s54, s54, 0x7fff
    v_mov_b32_dpp v26, v9 row_newbcast:8 row_mask:0xf bank_mask:0xf
    v_lshlrev_b32 v18, 16, v60
    v_and_b32 v19, s74, v60
    v_lshlrev_b32 v20, 16, v61
    v_and_b32 v21, s74, v61
    v_lshlrev_b32 v22, 16, v62
    v_and_b32 v23, s74, v62
    v_lshlrev_b32 v24, 16, v63
    v_and_b32 v25, s74, v63
    v_fmac_f32 v10, v26, v18
    v_fmac_f32 v11, v26, v19
    v_fmac_f32 v12, v26, v20
    v_fmac_f32 v13, v26, v21
    v_fmac_f32 v14, v26, v22
    v_fmac_f32 v15, v26, v23
    v_fmac_f32 v16, v26, v24
    v_fmac_f32 v17, v26, v25
    s_waitcnt vmcnt(3)
    buffer_load_dwordx4 v[80:83], v1, s[48:51], s54 offen nt
    s_add_u32 s54, s54, 1024
    s_and_b32 s54, s54, 0x7fff
    v_mov_b32_dpp v26, v9 row_newbcast:4 row_mask:0xf bank_mask:0xf
    v_lshlrev_b32 v18, 16, v64
    v_and_b32 v19, s74, v64
    v_lshlrev_b32 v20, 16, v65
    v_and_b32 v21, s74, v65
    v_lshlrev_b32 v22, 16, v66
    v_and_b32 v23, s74, v66
    v_lshlrev_b32 v24, 16, v67
    v_and_b32 v25, s74, v67
    v_fmac_f32 v10, v26, v18
    v_fmac_f32 v11, v26, v19
    v_fmac_f32 v12, v26, v20
    v_fmac_f32 v13, v26, v21
    v_fmac_f32 v14, v26, v22
    v_fmac_f32 v15, v26, v23
    v_fmac_f32 v16, v26, v24
    v_fmac_f32 v17, v26, v25
    s_waitcnt vmcnt(3)
    buffer_load_dwordx4 v[84:87], v1, s[48:51], s54 offen nt
    s_add_u32 s54, s54, 1024
    s_and_b32 s54, s54, 0x7fff
    v_mov_b32_dpp v26, v9 row_newbcast:12 row_mask:0xf bank_mask:0xf
    v_lshlrev_b32 v18, 16, v68
    v_and_b32 v19, s74, v68
    v_lshlrev_b32 v20, 16, v69
    v_and_b32 v21, s74, v69
    v_lshlrev_b32 v22, 16, v70
    v_and_b32 v23, s74, v70
    v_lshlrev_b32 v24, 16, v71
    v_and_b32 v25, s74, v71
    v_fmac_f32 v10, v26, v18
    v_fmac_f32 v11, v26, v19
    v_fmac_f32 v12, v26, v20
    v_fmac_f32 v13, v26, v21
    v_fmac_f32 v14, v26, v22
    v_fmac_f32 v15, v26, v23
    v_fmac_f32 v16, v26, v24
    v_fmac_f32 v17, v26, v25
    s_waitcnt vmcnt(3)
    buffer_load_dwordx4 v[88:91], v1, s[48:51], s54 offen nt
    s_add_u32 s54, s54, 1024
    s_and_b32 s54, s54, 0x7fff
    v_mov_b32 v27, 0
L_mx_2:
    ds_read_b128 v[28:31], v27 offset:256
    ds_read_b128 v[32:35], v27 offset:272
    s_waitcnt lgkmcnt(0)
    v_max3_u32 v36, v28, v29, v30
    v_max3_u32 v36, v36, v31, v32
    v_max3_u32 v36, v36, v33, v34
    v_max_u32 v36, v36, v35
    v_cmp_eq_u32 vcc, -1, v36
    s_cbranch_vccz L_mx_2_ok
    s_cmp_eq_u32 s38, 0
    s_cbranch_scc1 L_mx_2_ok
    s_sub_u32 s38, s38, 1
    s_branch L_mx_2
L_mx_2_ok:
    v_max3_f32 v36, v28, v29, v30
    v_max3_f32 v36, v36, v31, v32
    v_max3_f32 v36, v36, v33, v34
    v_max_f32 v36, v36, v35
    v_sub_f32 v37, s55, v36
    v_mul_f32 v37, 0x3fb8aa3b, v37
    v_exp_f32 v37, v37
    v_mov_b32 v38, 1
    v_and_b32 v2, 15, v0
    v_lshrrev_b32 v3, 4, v0
    v_lshl_add_u32 v2, v2, 2, v3
    v_lshlrev_b32 v2, 3, v2
    s_lshl_b32 s57, s3, 9
    v_add_u32 v2, s57, v2
    s_lshl_b32 s57, s3, 2
    v_mov_b32 v3, s57
    v_mul_f32 v39, s56, v37
    ds_write_b32 v3, v39 offset:288
    v_lshlrev_b32 v39, 3, v0
    s_lshl_b32 s61, s2, 9
    s_add_u32 s61, s61, 393216
    s_lshl_b32 s62, s2, 3
    s_add_u32 s62, s62, 53248
    s_lshl_b32 s63, s2, 2
    s_add_u32 s63, s63, 98304
    v_lshlrev_b32 v3, 10, v0
    v_mov_b32_dpp v26, v9 row_newbcast:2 row_mask:0xf bank_mask:0xf
    v_lshlrev_b32 v18, 16, v72
    v_and_b32 v19, s74, v72
    v_lshlrev_b32 v20, 16, v73
    v_and_b32 v21, s74, v73
    v_lshlrev_b32 v22, 16, v74
    v_and_b32 v23, s74, v74
    v_lshlrev_b32 v24, 16, v75
    v_and_b32 v25, s74, v75
    v_fmac_f32 v10, v26, v18
    v_fmac_f32 v11, v26, v19
    v_fmac_f32 v12, v26, v20
    v_fmac_f32 v13, v26, v21
    v_fmac_f32 v14, v26, v22
    v_fmac_f32 v15, v26, v23
    v_fmac_f32 v16, v26, v24
    v_fmac_f32 v17, v26, v25
    s_waitcnt vmcnt(3)
    buffer_load_dwordx4 v[92:95], v1, s[48:51], s54 offen nt
    s_add_u32 s54, s54, 1024
    s_and_b32 s54, s54, 0x7fff
    v_mov_b32_dpp v26, v9 row_newbcast:10 row_mask:0xf bank_mask:0xf
    v_lshlrev_b32 v18, 16, v76
    v_and_b32 v19, s74, v76
    v_lshlrev_b32 v20, 16, v77
    v_and_b32 v21, s74, v77
    v_lshlrev_b32 v22, 16, v78
    v_and_b32 v23, s74, v78
    v_lshlrev_b32 v24, 16, v79
    v_and_b32 v25, s74, v79
    v_fmac_f32 v10, v26, v18
    v_fmac_f32 v11, v26, v19
    v_fmac_f32 v12, v26, v20
    v_fmac_f32 v13, v26, v21
    v_fmac_f32 v14, v26, v22
    v_fmac_f32 v15, v26, v23
    v_fmac_f32 v16, v26, v24
    v_fmac_f32 v17, v26, v25
    buffer_load_dwordx4 v[96:99], v1, s[48:51], s54 offen nt
    s_add_u32 s54, s54, 1024
    s_and_b32 s54, s54, 0x7fff
    buffer_load_dwordx4 v[100:103], v1, s[48:51], s54 offen nt
    s_add_u32 s54, s54, 1024
    s_and_b32 s54, s54, 0x7fff
    s_waitcnt vmcnt(5)
    buffer_load_dwordx4 v[104:107], v1, s[48:51], s54 offen nt
    s_add_u32 s54, s54, 1024
    s_and_b32 s54, s54, 0x7fff
    v_mov_b32_dpp v26, v9 row_newbcast:6 row_mask:0xf bank_mask:0xf
    v_lshlrev_b32 v18, 16, v80
    v_and_b32 v19, s74, v80
    v_lshlrev_b32 v20, 16, v81
    v_and_b32 v21, s74, v81
    v_lshlrev_b32 v22, 16, v82
    v_and_b32 v23, s74, v82
    v_lshlrev_b32 v24, 16, v83
    v_and_b32 v25, s74, v83
    v_fmac_f32 v10, v26, v18
    v_fmac_f32 v11, v26, v19
    v_fmac_f32 v12, v26, v20
    v_fmac_f32 v13, v26, v21
    v_fmac_f32 v14, v26, v22
    v_fmac_f32 v15, v26, v23
    v_fmac_f32 v16, v26, v24
    v_fmac_f32 v17, v26, v25
    s_waitcnt vmcnt(5)
    buffer_load_dwordx4 v[108:111], v1, s[48:51], s54 offen nt
    s_add_u32 s54, s54, 1024
    s_and_b32 s54, s54, 0x7fff
    v_mov_b32_dpp v26, v9 row_newbcast:14 row_mask:0xf bank_mask:0xf
    v_lshlrev_b32 v18, 16, v84
    v_and_b32 v19, s74, v84
    v_lshlrev_b32 v20, 16, v85
    v_and_b32 v21, s74, v85
    v_lshlrev_b32 v22, 16, v86
    v_and_b32 v23, s74, v86
    v_lshlrev_b32 v24, 16, v87
    v_and_b32 v25, s74, v87
    v_fmac_f32 v10, v26, v18
    v_fmac_f32 v11, v26, v19
    v_fmac_f32 v12, v26, v20
    v_fmac_f32 v13, v26, v21
    v_fmac_f32 v14, v26, v22
    v_fmac_f32 v15, v26, v23
    v_fmac_f32 v16, v26, v24
    v_fmac_f32 v17, v26, v25
    s_waitcnt vmcnt(5)
    buffer_load_dwordx4 v[112:115], v1, s[48:51], s54 offen nt
    s_add_u32 s54, s54, 1024
    s_and_b32 s54, s54, 0x7fff
    v_mov_b32_dpp v26, v9 row_newbcast:1 row_mask:0xf bank_mask:0xf
    v_lshlrev_b32 v18, 16, v88
    v_and_b32 v19, s74, v88
    v_lshlrev_b32 v20, 16, v89
    v_and_b32 v21, s74, v89
    v_lshlrev_b32 v22, 16, v90
    v_and_b32 v23, s74, v90
    v_lshlrev_b32 v24, 16, v91
    v_and_b32 v25, s74, v91
    v_fmac_f32 v10, v26, v18
    v_fmac_f32 v11, v26, v19
    v_fmac_f32 v12, v26, v20
    v_fmac_f32 v13, v26, v21
    v_fmac_f32 v14, v26, v22
    v_fmac_f32 v15, v26, v23
    v_fmac_f32 v16, v26, v24
    v_fmac_f32 v17, v26, v25
    s_waitcnt vmcnt(5)
    buffer_load_dwordx4 v[116:119], v1, s[48:51], s54 offen nt
    s_add_u32 s54, s54, 1024
    s_and_b32 s54, s54, 0x7fff
    v_mov_b32_dpp v26, v9 row_newbcast:9 row_mask:0xf bank_mask:0xf
    v_lshlrev_b32 v18, 16, v92
    v_and_b32 v19, s74, v92
    v_lshlrev_b32 v20, 16, v93
    v_and_b32 v21, s74, v93
    v_lshlrev_b32 v22, 16, v94
    v_and_b32 v23, s74, v94
    v_lshlrev_b32 v24, 16, v95
    v_and_b32 v25, s74, v95
    v_fmac_f32 v10, v26, v18
    v_fmac_f32 v11, v26, v19
    v_fmac_f32 v12, v26, v20
    v_fmac_f32 v13, v26, v21
    v_fmac_f32 v14, v26, v22
    v_fmac_f32 v15, v26, v23
    v_fmac_f32 v16, v26, v24
    v_fmac_f32 v17, v26, v25
    s_waitcnt vmcnt(5)
    v_mov_b32_dpp v26, v9 row_newbcast:5 row_mask:0xf bank_mask:0xf
    v_lshlrev_b32 v18, 16, v96
    v_and_b32 v19, s74, v96
    v_lshlrev_b32 v20, 16, v97
    v_and_b32 v21, s74, v97
    v_lshlrev_b32 v22, 16, v98
    v_and_b32 v23, s74, v98
    v_lshlrev_b32 v24, 16, v99
    v_and_b32 v25, s74, v99
    v_fmac_f32 v10, v26, v18
    v_fmac_f32 v11, v26, v19
    v_fmac_f32 v12, v26, v20
    v_fmac_f32 v13, v26, v21
    v_fmac_f32 v14, v26, v22
    v_fmac_f32 v15, v26, v23
    v_fmac_f32 v16, v26, v24
    v_fmac_f32 v17, v26, v25
    s_waitcnt vmcnt(4)
    ds_write_b32 v27, v38 offset:396
    v_mov_b32_dpp v26, v9 row_newbcast:13 row_mask:0xf bank_mask:0xf
    v_lshlrev_b32 v18, 16, v100
    v_and_b32 v19, s74, v100
    v_lshlrev_b32 v20, 16, v101
    v_and_b32 v21, s74, v101
    v_lshlrev_b32 v22, 16, v102
    v_and_b32 v23, s74, v102
    v_lshlrev_b32 v24, 16, v103
    v_and_b32 v25, s74, v103
    v_fmac_f32 v10, v26, v18
    v_fmac_f32 v11, v26, v19
    v_fmac_f32 v12, v26, v20
    v_fmac_f32 v13, v26, v21
    v_fmac_f32 v14, v26, v22
    v_fmac_f32 v15, v26, v23
    v_fmac_f32 v16, v26, v24
    v_fmac_f32 v17, v26, v25
    s_waitcnt vmcnt(3)
    v_mov_b32_dpp v26, v9 row_newbcast:3 row_mask:0xf bank_mask:0xf
    v_lshlrev_b32 v18, 16, v104
    v_and_b32 v19, s74, v104
    v_lshlrev_b32 v20, 16, v105
    v_and_b32 v21, s74, v105
    v_lshlrev_b32 v22, 16, v106
    v_and_b32 v23, s74, v106
    v_lshlrev_b32 v24, 16, v107
    v_and_b32 v25, s74, v107
    v_fmac_f32 v10, v26, v18
    v_fmac_f32 v11, v26, v19
    v_fmac_f32 v12, v26, v20
    v_fmac_f32 v13, v26, v21
    v_fmac_f32 v14, v26, v22
    v_fmac_f32 v15, v26, v23
    v_fmac_f32 v16, v26, v24
    v_fmac_f32 v17, v26, v25
    s_waitcnt vmcnt(2)
    v_mov_b32_dpp v26, v9 row_newbcast:11 row_mask:0xf bank_mask:0xf
    v_lshlrev_b32 v18, 16, v108
    v_and_b32 v19, s74, v108
    v_lshlrev_b32 v20, 16, v109
    v_and_b32 v21, s74, v109
    v_lshlrev_b32 v22, 16, v110
    v_and_b32 v23, s74, v110
    v_lshlrev_b32 v24, 16, v111
    v_and_b32 v25, s74, v111
    v_fmac_f32 v10, v26, v18
    v_fmac_f32 v11, v26, v19
    v_fmac_f32 v12, v26, v20
    v_fmac_f32 v13, v26, v21
    v_fmac_f32 v14, v26, v22
    v_fmac_f32 v15, v26, v23
    v_fmac_f32 v16, v26, v24
    v_fmac_f32 v17, v26, v25
    s_waitcnt vmcnt(1)
    v_mov_b32_dpp v26, v9 row_newbcast:7 row_mask:0xf bank_mask:0xf
    v_lshlrev_b32 v18, 16, v112
    v_and_b32 v19, s74, v112
    v_lshlrev_b32 v20, 16, v113
    v_and_b32 v21, s74, v113
    v_lshlrev_b32 v22, 16, v114
    v_and_b32 v23, s74, v114
    v_lshlrev_b32 v24, 16, v115
    v_and_b32 v25, s74, v115
    v_fmac_f32 v10, v26, v18
    v_fmac_f32 v11, v26, v19
    v_fmac_f32 v12, v26, v20
    v_fmac_f32 v13, v26, v21
    v_fmac_f32 v14, v26, v22
    v_fmac_f32 v15, v26, v23
    v_fmac_f32 v16, v26, v24
    v_fmac_f32 v17, v26, v25
    s_waitcnt vmcnt(0)
    v_mov_b32_dpp v26, v9 row_newbcast:15 row_mask:0xf bank_mask:0xf
    v_lshlrev_b32 v18, 16, v116
    v_and_b32 v19, s74, v116
    v_lshlrev_b32 v20, 16, v117
    v_and_b32 v21, s74, v117
    v_lshlrev_b32 v22, 16, v118
    v_and_b32 v23, s74, v118
    v_lshlrev_b32 v24, 16, v119
    v_and_b32 v25, s74, v119
    v_fmac_f32 v10, v26, v18
    v_fmac_f32 v11, v26, v19
    v_fmac_f32 v12, v26, v20
    v_fmac_f32 v13, v26, v21
    v_fmac_f32 v14, v26, v22
    v_fmac_f32 v15, v26, v23
    v_fmac_f32 v16, v26, v24
    v_fmac_f32 v17, v26, v25
    v_permlane32_swap_b32 v10, v14
    v_permlane32_swap_b32 v11, v15
    v_permlane32_swap_b32 v12, v16
    v_permlane32_swap_b32 v13, v17
    v_add_f32 v10, v10, v14
    v_add_f32 v11, v11, v15
    v_add_f32 v12, v12, v16
    v_add_f32 v13, v13, v17
    s_nop 0
    v_permlane16_swap_b32 v10, v12
    v_permlane16_swap_b32 v11, v13
    v_add_f32 v10, v10, v12
    v_add_f32 v11, v11, v13
    v_mul_f32 v10, v10, v37
    v_mul_f32 v11, v11, v37
    v_mov_b32 v15, 1
    ds_write_b64 v2, v[10:11] offset:4096
    s_mov_b64 exec, 1
    ds_add_rtn_u32 v15, v27, v15 offset:388
    s_mov_b64 exec, -1
    s_waitcnt lgkmcnt(0)
    v_readfirstlane_b32 s57, v15
    s_cmp_lg_u32 s57, 7
    s_cbranch_scc1 L_s_pub_done
    ds_read_b64 v[40:41], v39 offset:4096
    ds_read_b64 v[42:43], v39 offset:4608
    ds_read_b64 v[44:45], v39 offset:5120
    ds_read_b64 v[46:47], v39 offset:5632
    ds_read_b64 v[48:49], v39 offset:6144
    ds_read_b64 v[50:51], v39 offset:6656
    ds_read_b64 v[52:53], v39 offset:7168
    ds_read_b64 v[54:55], v39 offset:7680
    ds_read_b128 v[56:59], v27 offset:288
    ds_read_b128 v[60:63], v27 offset:304
    v_mov_b32 v68, v36
    s_waitcnt lgkmcnt(2)
    v_add_f32 v64, v40, v42
    v_add_f32 v65, v41, v43
    v_add_f32 v72, v44, v46
    v_add_f32 v73, v45, v47
    v_add_f32 v74, v48, v50
    v_add_f32 v75, v49, v51
    v_add_f32 v76, v52, v54
    v_add_f32 v77, v53, v55
    v_add_f32 v64, v64, v72
    v_add_f32 v65, v65, v73
    v_add_f32 v74, v74, v76
    v_add_f32 v75, v75, v77
    v_add_f32 v64, v64, v74
    v_add_f32 v65, v65, v75
    buffer_store_dwordx2 v[64:65], v39, s[40:43], s61 offen sc1
    s_waitcnt lgkmcnt(0)
    v_add_f32 v56, v56, v57
    v_add_f32 v58, v58, v59
    v_add_f32 v60, v60, v61
    v_add_f32 v62, v62, v63
    v_add_f32 v56, v56, v58
    v_add_f32 v60, v60, v62
    v_add_f32 v69, v56, v60
    s_mov_b64 exec, 1
    buffer_store_dwordx2 v[68:69], v27, s[40:43], s62 offen sc1
    s_mov_b64 exec, 15
    buffer_store_dword v36, v3, s[40:43], s63 offen sc1
    s_mov_b64 exec, -1
    v_mov_b32 v15, 8
    ds_write_b32 v27, v15 offset:400
L_s_pub_done:
    v_mov_b32 v3, 0
L_ls_3:
    ds_read_b32 v2, v3 offset:392
    s_waitcnt lgkmcnt(0)
    v_cmp_ne_u32 vcc, -1, v2
    s_cbranch_vccnz L_ls_3_ok
    s_cmp_eq_u32 s38, 0
    s_cbranch_scc1 L_ls_3_ok
    s_sub_u32 s38, s38, 1
    s_sleep 2
    s_branch L_ls_3
L_ls_3_ok:
    s_lshr_b32 s57, s2, 3
    s_and_b32 s57, s57, 1
    v_readfirstlane_b32 s56, v2
    s_lshl_b32 s60, s57, 5
    s_add_u32 s60, s60, s56
    s_cmp_lt_u32 s56, 32
    s_cbranch_scc1 L_s_exit
    s_sub_u32 s60, 54, s57
    s_cmp_ge_u32 s56, s60
    s_cbranch_scc1 L_s_exit
    s_mul_i32 s60, s57, 22
    s_add_u32 s60, s60, s56
    s_sub_u32 s60, s60, 32
    s_branch L_s_ffn
L_s_ffn:
    s_barrier
    s_lshl_b32 s59, s3, 13
    s_add_u32 s59, s59, 24576
    v_lshrrev_b32 v4, 4, v0
    v_lshlrev_b32 v4, 3, v4
    v_and_b32 v5, 7, v0
    v_add_u32 v4, v4, v5
    v_mov_b32 v30, v4
    v_bfe_u32 v5, v0, 3, 1
    v_lshl_add_u32 v4, v5, 5, v4
    s_lshl_b32 s61, s3, 6
    v_add_u32 v5, s61, v4
    v_lshlrev_b32 v5, 2, v5
    v_lshlrev_b32 v30, 2, v30
    v_lshlrev_b32 v8, 2, v4
    s_lshl_b32 s61, s3, 8
    v_add_u32 v8, s61, v8
    v_lshrrev_b32 v9, 4, v0
    v_bfe_u32 v10, v0, 2, 2
    v_lshl_add_u32 v9, v9, 3, v10
    v_lshlrev_b32 v9, 6, v9
    v_and_b32 v10, 3, v0
    v_lshl_add_u32 v6, v10, 3, v9
    v_add_u32 v6, s59, v6
    v_lshrrev_b32 v9, 4, v0
    v_bfe_u32 v10, v0, 2, 2
    v_lshl_add_u32 v9, v9, 3, v10
    v_lshlrev_b32 v9, 7, v9
    v_and_b32 v10, 3, v0
    v_lshl_add_u32 v7, v10, 3, v9
    v_add_u32 v7, s59, v7
    v_and_b32 v31, 31, v0
    v_lshlrev_b32 v31, 2, v31
    s_lshl_b32 s61, s3, 7
    v_add_u32 v31, s61, v31
    s_lshl_b32 s61, s3, 3
    v_mov_b32 v32, s61
    v_and_b32 v33, 7, v0
    v_lshlrev_b32 v33, 3, v33
    v_mov_b32 v34, 0
    v_lshrrev_b32 v35, 4, v0
    s_lshl_b32 s61, s3, 2
    v_add_u32 v35, s61, v35
    v_mul_u32_u24 v35, 3072, v35
    v_and_b32 v36, 15, v0
    v_lshl_add_u32 v35, v36, 2, v35
    s_lshl_b32 s63, s60, 6
    s_add_u32 s63, s63, 655360
    s_and_b32 s52, s60, 0
    s_lshl_b32 s52, s52, 14
    s_add_u32 s52, s52, 65536
    s_add_u32 s53, s52, 4096
    s_add_u32 s54, s52, 8192
    s_add_u32 s55, s52, 12288
    s_barrier
    ds_read_b32 v40, v5 offset:10240
    ds_read_b32 v41, v5 offset:12288
    ds_read_b32 v42, v5 offset:14336
    ds_read_b32 v43, v5 offset:16384
    ds_read_b64_tr_b16 v[64:65], v6 offset:0
    ds_read_b64_tr_b16 v[66:67], v6 offset:256
    ds_read_b64_tr_b16 v[68:69], v6 offset:32
    ds_read_b64_tr_b16 v[70:71], v6 offset:288
    ds_read_b64_tr_b16 v[72:73], v6 offset:2048
    ds_read_b64_tr_b16 v[74:75], v6 offset:2304
    ds_read_b64_tr_b16 v[76:77], v6 offset:2080
    ds_read_b64_tr_b16 v[78:79], v6 offset:2336
    ds_read_b64_tr_b16 v[80:81], v7 offset:4096
    ds_read_b64_tr_b16 v[82:83], v7 offset:4608
    ds_read_b64_tr_b16 v[84:85], v7 offset:4128
    ds_read_b64_tr_b16 v[86:87], v7 offset:4640
    ds_read_b64_tr_b16 v[88:89], v7 offset:4160
    ds_read_b64_tr_b16 v[90:91], v7 offset:4672
    ds_read_b64_tr_b16 v[92:93], v7 offset:4192
    ds_read_b64_tr_b16 v[94:95], v7 offset:4704
    s_waitcnt lgkmcnt(0)
    s_mov_b64 s[8:9], -1
    s_mov_b64 s[10:11], -1
    s_mov_b64 s[12:13], -1
    s_mov_b64 s[14:15], -1
    s_mov_b64 s[16:17], -1
    s_mov_b64 s[18:19], -1
    s_mov_b64 s[20:21], -1
    s_mov_b64 s[22:23], -1
    s_mov_b64 exec, s[8:9]
    buffer_load_dword v96, v8, s[40:43], s52 offen offset:0 sc1
    s_mov_b64 exec, s[10:11]
    buffer_load_dword v97, v8, s[40:43], s52 offen offset:2048 sc1
    s_mov_b64 exec, s[12:13]
    buffer_load_dword v98, v8, s[40:43], s53 offen offset:0 sc1
    s_mov_b64 exec, s[14:15]
    buffer_load_dword v99, v8, s[40:43], s53 offen offset:2048 sc1
    s_mov_b64 exec, s[16:17]
    buffer_load_dword v100, v8, s[40:43], s54 offen offset:0 sc1
    s_mov_b64 exec, s[18:19]
    buffer_load_dword v101, v8, s[40:43], s54 offen offset:2048 sc1
    s_mov_b64 exec, s[20:21]
    buffer_load_dword v102, v8, s[40:43], s55 offen offset:0 sc1
    s_mov_b64 exec, s[22:23]
    buffer_load_dword v103, v8, s[40:43], s55 offen offset:2048 sc1
    s_mov_b64 exec, -1
    s_waitcnt vmcnt(0)
    v_cmp_eq_u32 s[8:9], -1, v96
    v_cmp_eq_u32 s[10:11], -1, v97
    v_cmp_eq_u32 s[12:13], -1, v98
    v_cmp_eq_u32 s[14:15], -1, v99
    v_cmp_eq_u32 s[16:17], -1, v100
    v_cmp_eq_u32 s[18:19], -1, v101
    v_cmp_eq_u32 s[20:21], -1, v102
    v_cmp_eq_u32 s[22:23], -1, v103
    s_or_b64 vcc, s[8:9], s[10:11]
    s_or_b64 vcc, vcc, s[12:13]
    s_or_b64 vcc, vcc, s[14:15]
    s_or_b64 vcc, vcc, s[16:17]
    s_or_b64 vcc, vcc, s[18:19]
    s_or_b64 vcc, vcc, s[20:21]
    s_or_b64 vcc, vcc, s[22:23]
    s_cbranch_vccz L_p3_4_d
    s_mov_b64 exec, s[8:9]
    buffer_load_dword v96, v8, s[40:43], s52 offen offset:0 sc1
    s_mov_b64 exec, s[10:11]
    buffer_load_dword v97, v8, s[40:43], s52 offen offset:2048 sc1
    s_mov_b64 exec, s[12:13]
    buffer_load_dword v98, v8, s[40:43], s53 offen offset:0 sc1
    s_mov_b64 exec, s[14:15]
    buffer_load_dword v99, v8, s[40:43], s53 offen offset:2048 sc1
    s_mov_b64 exec, s[16:17]
    buffer_load_dword v100, v8, s[40:43], s54 offen offset:0 sc1
    s_mov_b64 exec, s[18:19]
    buffer_load_dword v101, v8, s[40:43], s54 offen offset:2048 sc1
    s_mov_b64 exec, s[20:21]
    buffer_load_dword v102, v8, s[40:43], s55 offen offset:0 sc1
    s_mov_b64 exec, s[22:23]
    buffer_load_dword v103, v8, s[40:43], s55 offen offset:2048 sc1
    s_mov_b64 exec, -1
    s_sleep 8
L_p3_4:
    s_mov_b64 exec, s[8:9]
    buffer_load_dword v96, v8, s[40:43], s52 offen offset:0 sc1
    s_mov_b64 exec, s[10:11]
    buffer_load_dword v97, v8, s[40:43], s52 offen offset:2048 sc1
    s_mov_b64 exec, s[12:13]
    buffer_load_dword v98, v8, s[40:43], s53 offen offset:0 sc1
    s_mov_b64 exec, s[14:15]
    buffer_load_dword v99, v8, s[40:43], s53 offen offset:2048 sc1
    s_mov_b64 exec, s[16:17]
    buffer_load_dword v100, v8, s[40:43], s54 offen offset:0 sc1
    s_mov_b64 exec, s[18:19]
    buffer_load_dword v101, v8, s[40:43], s54 offen offset:2048 sc1
    s_mov_b64 exec, s[20:21]
    buffer_load_dword v102, v8, s[40:43], s55 offen offset:0 sc1
    s_mov_b64 exec, s[22:23]
    buffer_load_dword v103, v8, s[40:43], s55 offen offset:2048 sc1
    s_mov_b64 exec, -1
    s_waitcnt vmcnt(8)
    v_cmp_eq_u32 s[8:9], -1, v96
    v_cmp_eq_u32 s[10:11], -1, v97
    v_cmp_eq_u32 s[12:13], -1, v98
    v_cmp_eq_u32 s[14:15], -1, v99
    v_cmp_eq_u32 s[16:17], -1, v100
    v_cmp_eq_u32 s[18:19], -1, v101
    v_cmp_eq_u32 s[20:21], -1, v102
    v_cmp_eq_u32 s[22:23], -1, v103
    s_or_b64 vcc, s[8:9], s[10:11]
    s_or_b64 vcc, vcc, s[12:13]
    s_or_b64 vcc, vcc, s[14:15]
    s_or_b64 vcc, vcc, s[16:17]
    s_or_b64 vcc, vcc, s[18:19]
    s_or_b64 vcc, vcc, s[20:21]
    s_or_b64 vcc, vcc, s[22:23]
    s_cbranch_vccz L_p3_4_d
    s_cmp_eq_u32 s38, 0
    s_cbranch_scc1 L_p3_4_d
    s_sub_u32 s38, s38, 1
    s_branch L_p3_4
L_p3_4_d:
    v_add_f32 v10, v96, v97
    v_add_f32 v11, v98, v99
    v_add_f32 v12, v100, v101
    v_add_f32 v13, v102, v103
    v_add_f32 v10, v10, v11
    v_add_f32 v12, v12, v13
    v_add_f32 v10, v10, v12
    v_cvt_pk_bf16_f32 v10, v10, v10
    v_and_b32 v10, s74, v10
    v_mul_f32 v10, v41, v10
    v_cvt_pk_bf16_f32 v10, v10, v10
    v_and_b32 v10, s74, v10
    v_add_f32 v10, v40, v10
    v_cvt_pk_bf16_f32 v10, v10, v10
    v_and_b32 v10, s74, v10
    s_nop 0
    v_readfirstlane_b32 s61, v10
    ds_write_b32 v5, v10 offset:20480
    s_nop 0
    v_subrev_f32 v12, s61, v10
    v_mul_f32 v13, v12, v12
    s_nop 0
    v_add_f32_dpp v12, v12, v12 row_ror:8 row_mask:0xf bank_mask:0xf
    v_add_f32_dpp v13, v13, v13 row_ror:8 row_mask:0xf bank_mask:0xf
    s_nop 0
    v_add_f32_dpp v12, v12, v12 row_ror:4 row_mask:0xf bank_mask:0xf
    v_add_f32_dpp v13, v13, v13 row_ror:4 row_mask:0xf bank_mask:0xf
    s_nop 0
    v_add_f32_dpp v12, v12, v12 row_ror:2 row_mask:0xf bank_mask:0xf
    v_add_f32_dpp v13, v13, v13 row_ror:2 row_mask:0xf bank_mask:0xf
    s_nop 0
    v_add_f32_dpp v12, v12, v12 row_ror:1 row_mask:0xf bank_mask:0xf
    v_add_f32_dpp v13, v13, v13 row_ror:1 row_mask:0xf bank_mask:0xf
    s_nop 0
    v_add_f32_dpp v12, v12, v12 row_bcast:15 row_mask:0xa bank_mask:0xf
    v_add_f32_dpp v13, v13, v13 row_bcast:15 row_mask:0xa bank_mask:0xf
    s_nop 0
    v_add_f32_dpp v12, v12, v12 row_bcast:31 row_mask:0xc bank_mask:0xf
    v_add_f32_dpp v13, v13, v13 row_bcast:31 row_mask:0xc bank_mask:0xf
    v_mul_f32 v14, 0x3c800000, v12
    v_fma_f32 v15, -v14, v12, v13
    v_add_f32 v14, s61, v14
    s_mov_b32 exec_lo, 0
    s_mov_b32 exec_hi, 0x80000000
    ds_write_b64 v32, v[14:15] offset:320
    s_mov_b64 exec, -1
    s_waitcnt lgkmcnt(0)
    s_barrier
    ds_read_b64 v[18:19], v33 offset:320
    ds_read_b32 v20, v34 offset:320
    s_waitcnt lgkmcnt(0)
    v_sub_f32 v18, v18, v20
    v_mul_f32 v21, v18, v18
    v_fmac_f32 v19, 0x42800000, v21
    v_add_f32_dpp v18, v18, v18 row_half_mirror row_mask:0xf bank_mask:0xf
    s_nop 0
    v_add_f32_dpp v19, v19, v19 row_half_mirror row_mask:0xf bank_mask:0xf
    v_add_f32_dpp v18, v18, v18 quad_perm:[2,3,0,1] row_mask:0xf bank_mask:0xf
    s_nop 0
    v_add_f32_dpp v19, v19, v19 quad_perm:[2,3,0,1] row_mask:0xf bank_mask:0xf
    v_add_f32_dpp v18, v18, v18 quad_perm:[1,0,3,2] row_mask:0xf bank_mask:0xf
    s_nop 0
    v_add_f32_dpp v19, v19, v19 quad_perm:[1,0,3,2] row_mask:0xf bank_mask:0xf
    v_mul_f32 v21, v18, v18
    v_fmac_f32 v20, 0x3e000000, v18
    v_fmac_f32 v19, 0xc1000000, v21
    v_mul_f32 v19, 0x3b000000, v19
    v_max_f32 v19, 0, v19
    v_cvt_pk_bf16_f32 v21, v20, v19
    v_lshlrev_b32 v20, 16, v21
    v_and_b32 v19, s74, v21
    v_add_f32 v19, 0x3727c5ac, v19
    v_sub_f32 v22, v10, v20
    v_cvt_pk_bf16_f32 v19, v19, v19
    v_and_b32 v19, s74, v19
    v_sqrt_f32 v24, v19
    v_cvt_pk_bf16_f32 v22, v22, v22
    v_and_b32 v22, s74, v22
    v_cvt_pk_bf16_f32 v24, v24, v24
    v_and_b32 v24, s74, v24
    v_rcp_f32 v25, v24
    s_nop 0
    v_mul_f32 v21, v22, v25
    v_fma_f32 v22, -v21, v24, v22
    v_fma_f32 v22, v22, v25, v21
    v_cvt_pk_bf16_f32 v22, v22, v22
    v_and_b32 v22, s74, v22
    v_mul_f32 v22, v22, v43
    v_cvt_pk_bf16_f32 v22, v22, v22
    v_and_b32 v22, s74, v22
    v_add_f32 v22, v22, v42
    s_nop 1
    v_mov_b32_dpp v23, v22 quad_perm:[1,1,3,3] row_mask:0xf bank_mask:0xf
    v_cvt_pk_bf16_f32 v24, v22, v23
    s_nop 1
    v_mov_b32_dpp v112, v24 row_newbcast:0 row_mask:0xf bank_mask:0xf
    v_mov_b32_dpp v113, v24 row_newbcast:2 row_mask:0xf bank_mask:0xf
    v_mov_b32_dpp v114, v24 row_newbcast:4 row_mask:0xf bank_mask:0xf
    v_mov_b32_dpp v115, v24 row_newbcast:6 row_mask:0xf bank_mask:0xf
    v_mov_b32_dpp v116, v24 row_newbcast:8 row_mask:0xf bank_mask:0xf
    v_mov_b32_dpp v117, v24 row_newbcast:10 row_mask:0xf bank_mask:0xf
    v_mov_b32_dpp v118, v24 row_newbcast:12 row_mask:0xf bank_mask:0xf
    v_mov_b32_dpp v119, v24 row_newbcast:14 row_mask:0xf bank_mask:0xf
    v_mfma_f32_16x16x32_bf16 v[120:123], v[112:115], v[64:67], 0
    v_mfma_f32_16x16x32_bf16 v[124:127], v[112:115], v[68:71], 0
    v_mfma_f32_16x16x32_bf16 v[120:123], v[116:119], v[72:75], v[120:123]
    v_mfma_f32_16x16x32_bf16 v[124:127], v[116:119], v[76:79], v[124:127]
    s_nop 7
    v_cndmask_b32 v29, v120, v124, s[68:69]
    s_mov_b32 exec_hi, 0
    ds_write_b32 v31, v29 offset:9216
    s_mov_b64 exec, -1
    s_waitcnt lgkmcnt(0)
    s_barrier
    ds_read_b32 v44, v30 offset:9216
    ds_read_b32 v45, v30 offset:9344
    ds_read_b32 v46, v30 offset:9472
    ds_read_b32 v47, v30 offset:9600
    ds_read_b32 v48, v30 offset:9728
    ds_read_b32 v49, v30 offset:9856
    ds_read_b32 v50, v30 offset:9984
    ds_read_b32 v51, v30 offset:10112
    s_waitcnt lgkmcnt(0)
    v_add_f32 v44, v44, v45
    v_add_f32 v46, v46, v47
    v_add_f32 v48, v48, v49
    v_add_f32 v50, v50, v51
    v_add_f32 v44, v44, v46
    v_add_f32 v48, v48, v50
    v_add_f32 v44, v44, v48
    v_max_f32 v44, 0, v44
    s_nop 1
    v_mov_b32_dpp v45, v44 quad_perm:[1,1,3,3] row_mask:0xf bank_mask:0xf
    v_cvt_pk_bf16_f32 v46, v44, v45
    s_nop 1
    v_mov_b32_dpp v112, v46 row_newbcast:0 row_mask:0xf bank_mask:0xf
    v_mov_b32_dpp v113, v46 row_newbcast:2 row_mask:0xf bank_mask:0xf
    v_mov_b32_dpp v114, v46 row_newbcast:4 row_mask:0xf bank_mask:0xf
    v_mov_b32_dpp v115, v46 row_newbcast:6 row_mask:0xf bank_mask:0xf
    s_nop 1
    v_mfma_f32_16x16x32_bf16 v[120:123], v[112:115], v[80:83], 0
    v_mfma_f32_16x16x32_bf16 v[124:127], v[112:115], v[84:87], 0
    v_mfma_f32_16x16x32_bf16 v[128:131], v[112:115], v[88:91], 0
    v_mfma_f32_16x16x32_bf16 v[132:135], v[112:115], v[92:95], 0
    s_nop 5
    v_cndmask_b32 v40, v120, v124, s[68:69]
    v_cndmask_b32 v40, v40, v128, s[70:71]
    v_cndmask_b32 v40, v40, v132, s[72:73]
    buffer_store_dword v40, v35, s[40:43], s63 offen sc1
    s_cmp_lg_u32 s3, 0
    s_cbranch_scc1 L_s_exit
    s_cmp_ge_u32 s60, 32
    s_cbranch_scc1 L_s_exit
    v_lshlrev_b32 v8, 3, v0
    s_mul_i32 s61, s60, 3072
    s_add_u32 s61, s61, 655360
    v_and_b32 v9, 7, v0
    s_lshl_b32 s62, s60, 6
    v_lshl_add_u32 v9, v9, 3, s62
    ds_read_b64 v[10:11], v9 offset:20480
    ds_read_b64 v[12:13], v9 offset:18432
    v_mov_b32 v58, 0
    v_mov_b32 v59, 0
    v_mov_b32 v74, 0
    v_mov_b32 v75, 0
    v_and_b32 v14, 7, v0
    v_lshlrev_b32 v14, 2, v14
    s_lshl_b32 s62, s60, 5
    s_mov_b32 s44, s28
    s_mov_b32 s45, s29
    s_mov_b32 s46, 1024
    s_mov_b32 s47, 0x20000
    s_mov_b64 s[8:9], -1
    s_mov_b64 s[10:11], -1
    s_mov_b64 s[12:13], -1
    s_mov_b64 s[14:15], -1
    s_mov_b64 s[16:17], -1
    s_mov_b64 s[18:19], 0xffffff
    s_mov_b64 exec, s[8:9]
    buffer_load_dwordx2 v[48:49], v8, s[40:43], s61 offen offset:0 sc1
    s_mov_b64 exec, s[10:11]
    buffer_load_dwordx2 v[50:51], v8, s[40:43], s61 offen offset:512 sc1
    s_mov_b64 exec, s[12:13]
    buffer_load_dwordx2 v[52:53], v8, s[40:43], s61 offen offset:1024 sc1
    s_mov_b64 exec, s[14:15]
    buffer_load_dwordx2 v[54:55], v8, s[40:43], s61 offen offset:1536 sc1
    s_mov_b64 exec, s[16:17]
    buffer_load_dwordx2 v[56:57], v8, s[40:43], s61 offen offset:2048 sc1
    s_mov_b64 exec, s[18:19]
    buffer_load_dwordx2 v[58:59], v8, s[40:43], s61 offen offset:2560 sc1
    s_mov_b64 exec, -1
    s_sleep 8
L_p3_5:
    s_mov_b64 exec, s[8:9]
    buffer_load_dwordx2 v[48:49], v8, s[40:43], s61 offen offset:0 sc1
    s_mov_b64 exec, s[10:11]
    buffer_load_dwordx2 v[50:51], v8, s[40:43], s61 offen offset:512 sc1
    s_mov_b64 exec, s[12:13]
    buffer_load_dwordx2 v[52:53], v8, s[40:43], s61 offen offset:1024 sc1
    s_mov_b64 exec, s[14:15]
    buffer_load_dwordx2 v[54:55], v8, s[40:43], s61 offen offset:1536 sc1
    s_mov_b64 exec, s[16:17]
    buffer_load_dwordx2 v[56:57], v8, s[40:43], s61 offen offset:2048 sc1
    s_mov_b64 exec, s[18:19]
    buffer_load_dwordx2 v[58:59], v8, s[40:43], s61 offen offset:2560 sc1
    s_mov_b64 exec, -1
    s_waitcnt vmcnt(6)
    v_max_u32 v2, v48, v49
    v_cmp_eq_u32 s[8:9], -1, v2
    v_max_u32 v2, v50, v51
    v_cmp_eq_u32 s[10:11], -1, v2
    v_max_u32 v2, v52, v53
    v_cmp_eq_u32 s[12:13], -1, v2
    v_max_u32 v2, v54, v55
    v_cmp_eq_u32 s[14:15], -1, v2
    v_max_u32 v2, v56, v57
    v_cmp_eq_u32 s[16:17], -1, v2
    v_max_u32 v2, v58, v59
    v_cmp_eq_u32 s[18:19], -1, v2
    s_or_b64 vcc, s[8:9], s[10:11]
    s_or_b64 vcc, vcc, s[12:13]
    s_or_b64 vcc, vcc, s[14:15]
    s_or_b64 vcc, vcc, s[16:17]
    s_or_b64 vcc, vcc, s[18:19]
    s_cbranch_vccz L_p3_5_d
    s_cmp_eq_u32 s38, 0
    s_cbranch_scc1 L_p3_5_d
    s_sub_u32 s38, s38, 1
    s_branch L_p3_5
L_p3_5_d:
    v_add_f32 v80, v48, v50
    v_add_f32 v81, v49, v51
    v_add_f32 v82, v52, v54
    v_add_f32 v83, v53, v55
    v_add_f32 v84, v56, v58
    v_add_f32 v85, v57, v59
    v_add_f32 v80, v80, v82
    v_add_f32 v81, v81, v83
    v_add_f32 v80, v80, v84
    v_add_f32 v81, v81, v85
    s_nop 0
    v_add_f32_dpp v80, v80, v80 row_ror:8 row_mask:0xf bank_mask:0xf
    v_add_f32_dpp v81, v81, v81 row_ror:8 row_mask:0xf bank_mask:0xf
    v_mov_b32 v82, v80
    v_mov_b32 v83, v81
    s_nop 0
    v_permlane16_swap_b32 v80, v82
    v_permlane16_swap_b32 v81, v83
    v_add_f32 v80, v80, v82
    v_add_f32 v81, v81, v83
    v_mov_b32 v82, v80
    v_mov_b32 v83, v81
    s_nop 0
    v_permlane32_swap_b32 v80, v82
    v_permlane32_swap_b32 v81, v83
    v_add_f32 v80, v80, v82
    v_add_f32 v81, v81, v83
    s_waitcnt lgkmcnt(0)
    v_cvt_pk_bf16_f32 v82, v80, v81
    v_lshlrev_b32 v80, 16, v82
    v_and_b32 v81, s74, v82
    v_mul_f32 v80, v12, v80
    v_mul_f32 v81, v13, v81
    v_cvt_pk_bf16_f32 v82, v80, v81
    v_lshlrev_b32 v80, 16, v82
    v_and_b32 v81, s74, v82
    v_add_f32 v80, v10, v80
    v_add_f32 v81, v11, v81
    v_cvt_pk_bf16_f32 v82, v80, v81
    s_mov_b64 exec, 0xff
    buffer_store_dword v82, v14, s[44:47], s62 offen
    s_cmp_lg_u32 s60, 0
    s_cbranch_scc1 L_s_exit
    s_mov_b64 exec, 1
    v_mov_b32 v52, s34
    v_mov_b32 v53, s35
    v_mov_b32 v54, 0
    buffer_store_dwordx2 v[52:53], v54, s[40:43], 0 offen sc1
L_s_exit:
    s_endpgm
L_ctl:
    v_lshlrev_b32 v1, 4, v0
    s_sub_u32 s3, s3, 8
    s_lshl_b32 s59, s3, 14
    s_add_u32 s59, s59, 24576
    s_lshl_b32 s58, s3, 8
    s_add_u32 s58, s58, 2560
    s_cmp_eq_u32 s3, 1
    s_cbranch_scc1 L_c1
    s_waitcnt lgkmcnt(0)
    s_load_dwordx2 s[34:35], s[32:33], 0
    s_mov_b32 s40, s32
    s_mov_b32 s41, s33
    s_mov_b32 s42, 1048576
    s_mov_b32 s43, 0x20000
    s_mov_b32 s74, 0xffff0000
    s_mov_b32 s38, 0x40000
    s_mov_b32 s64, 0xcccccccc
    s_mov_b32 s65, 0xcccccccc
    s_mov_b32 s66, 0xaaaaaaaa
    s_mov_b32 s67, 0xaaaaaaaa
    s_mov_b32 s68, 0xffff0000
    s_mov_b32 s69, 0
    s_mov_b32 s70, 0
    s_mov_b32 s71, 0xffff
    s_mov_b32 s72, 0
    s_mov_b32 s73, 0xffff0000
    s_mov_b32 s75, 0
    s_barrier
    s_cmp_eq_u32 s3, 0
    s_cbranch_scc1 L_c0
    s_cmp_eq_u32 s3, 2
    s_cbranch_scc0 L_c3
    v_mov_b32 v2, -1
    v_lshlrev_b32 v3, 2, v0
    s_mov_b64 exec, 0xff
    ds_write_b32 v3, v2 offset:256
    s_mov_b64 exec, 1
    v_mov_b32 v2, 0
    ds_write_b32 v2, v2 offset:388
    ds_write_b32 v2, v2 offset:396
    ds_write_b32 v2, v2 offset:400
    v_mov_b32 v3, -1
    ds_write_b32 v2, v3 offset:392
    s_mov_b64 exec, -1
    v_mov_b32 v8, -1
    v_mov_b32 v9, -1
    v_mov_b32 v10, -1
    v_mov_b32 v11, -1
    s_lshl_b32 s56, s2, 9
    s_add_u32 s56, s56, 393216
    s_lshl_b32 s57, s2, 3
    s_add_u32 s57, s57, 53248
    v_mov_b32 v12, 0
    s_mov_b32 exec_hi, 0
    buffer_store_dwordx4 v[8:11], v1, s[40:43], s56 offen sc1
    s_mov_b64 exec, 1
    buffer_store_dwordx2 v[8:9], v12, s[40:43], s57 offen sc1
    s_mov_b64 exec, -1
    s_lshl_b32 s56, s2, 2
    s_add_u32 s56, s56, 98304
    v_lshlrev_b32 v13, 10, v0
    s_mov_b64 exec, 15
    buffer_store_dword v8, v13, s[40:43], s56 offen sc1
    s_mov_b64 exec, -1
    s_cmp_ge_u32 s2, 64
    s_cbranch_scc1 L_clr_6
    s_lshl_b32 s56, s2, 8
    s_add_u32 s56, s56, 65536
    s_mov_b64 exec, 0xffff
    buffer_store_dwordx4 v[8:11], v1, s[40:43], s56 offen sc1
    s_mov_b64 exec, -1
L_clr_6:
    s_cmp_lt_u32 s2, 192
    s_cbranch_scc1 L_clr_8
    s_cmp_ge_u32 s2, 224
    s_cbranch_scc1 L_clr_8
    s_sub_u32 s56, s2, 192
    s_lshl_b32 s56, s56, 7
    s_add_u32 s56, s56, 36864
    s_mov_b64 exec, 0xff
    buffer_store_dwordx4 v[8:11], v1, s[40:43], s56 offen sc1
    s_mov_b64 exec, -1
L_clr_8:
    s_cmp_ge_u32 s2, 43
    s_cbranch_scc1 L_clr_7
    v_lshrrev_b32 v13, 2, v0
    v_mul_u32_u24 v13, 3072, v13
    v_and_b32 v14, 3, v0
    v_lshl_add_u32 v13, v14, 4, v13
    s_lshl_b32 s56, s2, 6
    s_add_u32 s56, s56, 655360
    s_add_u32 s57, s56, 49152
    buffer_store_dwordx4 v[8:11], v13, s[40:43], s56 offen sc1
    buffer_store_dwordx4 v[8:11], v13, s[40:43], s57 offen sc1
L_clr_7:
    s_waitcnt vmcnt(0) lgkmcnt(0)
    s_cmp_eq_u32 s75, 1
    s_cbranch_scc1 L_ep_9
    s_add_u32 s34, s34, 1
    s_addc_u32 s35, s35, 0
    s_xor_b32 s36, s34, 0x5bd1e995
    s_xor_b32 s37, s35, 0x9e3779b9
    s_mov_b32 s75, 1
L_ep_9:
    v_mov_b32 v16, 0
    v_mov_b32 v17, 0
    v_mov_b32 v18, s36
    v_mov_b32 v19, s37
    s_lshl_b32 s56, s2, 4
    s_add_u32 s56, s56, 4096
    s_mov_b64 exec, 1
    buffer_store_dwordx4 v[16:19], v12, s[40:43], s56 offen sc1
    s_mov_b64 exec, -1
    s_cmp_lt_u32 s2, 192
    s_cbranch_scc1 L_c_b1
    s_cmp_ge_u32 s2, 224
    s_cbranch_scc1 L_c_b1
    v_mov_b32 v3, 0
L_ls_10:
    ds_read_b32 v2, v3 offset:384
    s_waitcnt lgkmcnt(0)
    v_cmp_eq_u32 vcc, s36, v2
    s_cbranch_vccnz L_ls_10_ok
    s_cmp_eq_u32 s38, 0
    s_cbranch_scc1 L_ls_10_ok
    s_sub_u32 s38, s38, 1
    s_sleep 16
    s_branch L_ls_10
L_ls_10_ok:
    s_sub_u32 s60, s2, 192
    s_lshl_b32 s56, s60, 11
    s_add_u32 s56, s56, 884736
    s_lshl_b32 s57, s60, 7
    s_add_u32 s57, s57, 36864
L_poll_11:
    buffer_load_dwordx4 v[8:11], v1, s[40:43], s56 offen sc1
    buffer_load_dwordx4 v[12:15], v1, s[40:43], s56 offen offset:1024 sc1
    s_waitcnt vmcnt(0)
    v_xor_b32 v2, s36, v10
    v_bitop3_b32 v2, v2, s37, v11 bitop3:0xf6
    v_bitop3_b32 v2, v2, s36, v14 bitop3:0xf6
    v_bitop3_b32 v2, v2, s37, v15 bitop3:0xf6
    v_cmp_ne_u32 vcc, 0, v2
    s_cbranch_vccz L_pok_12
    s_cmp_eq_u32 s38, 0
    s_cbranch_scc1 L_pok_12
    s_sub_u32 s38, s38, 1
    s_sleep 32
    s_branch L_poll_11
L_pok_12:
    v_add_f32 v16, v8, v12
    v_add_f32 v17, v9, v13
    v_mov_b32 v20, v16
    s_nop 1
    v_permlane32_swap_b32 v16, v20
    v_add_f32 v16, v16, v20
    v_mov_b32 v21, v17
    s_nop 1
    v_permlane32_swap_b32 v17, v21
    v_add_f32 v17, v17, v21
    v_cvt_pk_bf16_f32 v18, v16, v17
    v_lshlrev_b32 v19, 2, v0
    s_mov_b32 exec_hi, 0
    buffer_store_dword v18, v19, s[40:43], s57 offen sc1
    s_mov_b64 exec, -1
    s_branch L_c_b1
L_c3:
    v_and_b32 v2, 7, v0
    s_lshl_b32 s52, s2, 3
    v_add_u32 v2, s52, v2
    v_lshlrev_b32 v2, 15, v2
    global_load_dword v8, v2, s[12:13]
    s_branch L_c_b1
L_c1:
    s_mov_b32 s39, 0
    s_cmp_lt_u32 s2, 64
    s_cbranch_scc1 L_unit
    s_waitcnt lgkmcnt(0)
    s_load_dwordx2 s[34:35], s[32:33], 0
    s_mov_b32 s40, s32
    s_mov_b32 s41, s33
    s_mov_b32 s42, 1048576
    s_mov_b32 s43, 0x20000
    s_mov_b32 s74, 0xffff0000
    s_mov_b32 s38, 0x40000
    s_mov_b32 s64, 0xcccccccc
    s_mov_b32 s65, 0xcccccccc
    s_mov_b32 s66, 0xaaaaaaaa
    s_mov_b32 s67, 0xaaaaaaaa
    s_mov_b32 s68, 0xffff0000
    s_mov_b32 s69, 0
    s_mov_b32 s70, 0
    s_mov_b32 s71, 0xffff
    s_mov_b32 s72, 0
    s_mov_b32 s73, 0xffff0000
    s_mov_b32 s75, 0
    s_barrier
    s_cmp_ge_u32 s2, 192
    s_cbranch_scc1 L_c_b1
    s_waitcnt lgkmcnt(0)
    s_cmp_eq_u32 s75, 1
    s_cbranch_scc1 L_ep_14
    s_add_u32 s34, s34, 1
    s_addc_u32 s35, s35, 0
    s_xor_b32 s36, s34, 0x5bd1e995
    s_xor_b32 s37, s35, 0x9e3779b9
    s_mov_b32 s75, 1
L_ep_14:
    v_mov_b32 v9, 0
L_hint_13:
    ds_read_b32 v8, v9 offset:384
    s_waitcnt lgkmcnt(0)
    v_cmp_eq_u32 vcc, s36, v8
    s_cbranch_vccnz L_hint_13_ok
    s_cmp_eq_u32 s38, 0
    s_cbranch_scc1 L_hint_13_ok
    s_sub_u32 s38, s38, 1
    s_sleep 8
    s_branch L_hint_13
L_hint_13_ok:
    s_mov_b32 s39, 1
L_unit:
    s_lshr_b32 s61, s2, 2
    s_lshl_b32 s61, s61, 7
    s_and_b32 s60, s2, 3
    s_lshl_b32 s60, s60, 7
    v_lshrrev_b32 v4, 3, v0
    v_mul_u32_u24 v4, 6144, v4
    v_and_b32 v5, 7, v0
    v_lshl_add_u32 v4, v5, 4, v4
    v_add_u32 v4, s61, v4
    v_lshlrev_b32 v5, 2, v0
    s_lshl_b32 s56, s60, 1
    s_mul_i32 s57, s60, 6144
    s_waitcnt lgkmcnt(0)
    s_mov_b32 s44, s26
    s_mov_b32 s45, s27
    s_mov_b32 s46, 3145728
    s_mov_b32 s47, 0x20000
    s_mov_b32 s48, s24
    s_mov_b32 s49, s25
    s_mov_b32 s50, 1024
    s_mov_b32 s51, 0x20000
    buffer_load_dword v10, v5, s[48:51], s56 offen
    s_mov_b32 s53, s57
    s_mov_b32 m0, s59
    s_nop 0
    buffer_load_dwordx4 v4, s[44:47], s53 offen nt lds
    s_add_u32 s53, s53, 49152
    s_add_u32 m0, m0, 1024
    s_nop 0
    buffer_load_dwordx4 v4, s[44:47], s53 offen nt lds
    s_add_u32 s53, s53, 49152
    s_add_u32 m0, m0, 1024
    s_nop 0
    buffer_load_dwordx4 v4, s[44:47], s53 offen nt lds
    s_add_u32 s53, s53, 49152
    s_add_u32 m0, m0, 1024
    s_nop 0
    buffer_load_dwordx4 v4, s[44:47], s53 offen nt lds
    s_add_u32 s53, s53, 49152
    s_add_u32 m0, m0, 1024
    s_nop 0
    buffer_load_dwordx4 v4, s[44:47], s53 offen nt lds
    s_add_u32 s53, s53, 49152
    s_add_u32 m0, m0, 1024
    s_nop 0
    buffer_load_dwordx4 v4, s[44:47], s53 offen nt lds
    s_add_u32 s53, s53, 49152
    s_add_u32 m0, m0, 1024
    s_nop 0
    buffer_load_dwordx4 v4, s[44:47], s53 offen nt lds
    s_add_u32 s53, s53, 49152
    s_add_u32 m0, m0, 1024
    s_nop 0
    buffer_load_dwordx4 v4, s[44:47], s53 offen nt lds
    s_add_u32 s53, s53, 49152
    s_add_u32 m0, m0, 1024
    s_nop 0
    buffer_load_dwordx4 v4, s[44:47], s53 offen nt lds
    s_add_u32 s53, s53, 49152
    s_add_u32 m0, m0, 1024
    s_nop 0
    buffer_load_dwordx4 v4, s[44:47], s53 offen nt lds
    s_add_u32 s53, s53, 49152
    s_add_u32 m0, m0, 1024
    s_nop 0
    buffer_load_dwordx4 v4, s[44:47], s53 offen nt lds
    s_add_u32 s53, s53, 49152
    s_add_u32 m0, m0, 1024
    s_nop 0
    buffer_load_dwordx4 v4, s[44:47], s53 offen nt lds
    s_add_u32 s53, s53, 49152
    s_add_u32 m0, m0, 1024
    s_nop 0
    buffer_load_dwordx4 v4, s[44:47], s53 offen nt lds
    s_add_u32 s53, s53, 49152
    s_add_u32 m0, m0, 1024
    s_nop 0
    buffer_load_dwordx4 v4, s[44:47], s53 offen nt lds
    s_add_u32 s53, s53, 49152
    s_add_u32 m0, m0, 1024
    s_nop 0
    buffer_load_dwordx4 v4, s[44:47], s53 offen nt lds
    s_add_u32 s53, s53, 49152
    s_add_u32 m0, m0, 1024
    s_nop 0
    buffer_load_dwordx4 v4, s[44:47], s53 offen nt lds
    s_cmp_eq_u32 s39, 1
    s_cbranch_scc1 L_unit_go
    s_barrier
    s_waitcnt lgkmcnt(0)
    s_load_dwordx2 s[34:35], s[32:33], 0
    s_mov_b32 s40, s32
    s_mov_b32 s41, s33
    s_mov_b32 s42, 1048576
    s_mov_b32 s43, 0x20000
    s_mov_b32 s74, 0xffff0000
    s_mov_b32 s38, 0x40000
    s_mov_b32 s64, 0xcccccccc
    s_mov_b32 s65, 0xcccccccc
    s_mov_b32 s66, 0xaaaaaaaa
    s_mov_b32 s67, 0xaaaaaaaa
    s_mov_b32 s68, 0xffff0000
    s_mov_b32 s69, 0
    s_mov_b32 s70, 0
    s_mov_b32 s71, 0xffff
    s_mov_b32 s72, 0
    s_mov_b32 s73, 0xffff0000
    s_mov_b32 s75, 0
L_unit_go:
    v_lshrrev_b32 v8, 4, v0
    v_bfe_u32 v9, v0, 2, 2
    v_lshl_add_u32 v8, v8, 3, v9
    v_lshlrev_b32 v8, 7, v8
    v_and_b32 v9, 3, v0
    v_lshl_add_u32 v6, v9, 3, v8
    v_add_u32 v6, s59, v6
    v_lshrrev_b32 v7, 4, v0
    v_lshl_add_u32 v7, v7, 4, s58
    v_lshl_add_u32 v12, v0, 2, s58
    s_waitcnt vmcnt(16)
    v_lshlrev_b32 v8, 16, v10
    v_and_b32 v9, s74, v10
    v_mul_f32 v10, 0xbfb8aa3b, v8
    v_mul_f32 v11, 0xbfb8aa3b, v9
    v_exp_f32 v10, v10
    v_exp_f32 v11, v11
    v_add_f32 v10, 1.0, v10
    v_add_f32 v11, 1.0, v11
    v_min_f32 v10, 0x7f7fffff, v10
    v_min_f32 v11, 0x7f7fffff, v11
    v_rcp_f32 v13, v10
    v_rcp_f32 v14, v11
    v_mul_f32 v15, v8, v13
    v_mul_f32 v16, v9, v14
    v_fma_f32 v17, -v15, v10, v8
    v_fma_f32 v18, -v16, v11, v9
    v_fma_f32 v17, v17, v13, v15
    v_fma_f32 v18, v18, v14, v16
    v_cvt_pk_bf16_f32 v10, v17, v18
    ds_write_b32 v12, v10
    s_waitcnt lgkmcnt(0)
    ds_read_b128 v[108:111], v7 offset:0
    ds_read_b128 v[112:115], v7 offset:64
    ds_read_b128 v[116:119], v7 offset:128
    ds_read_b128 v[120:123], v7 offset:192
    s_waitcnt vmcnt(0)
    ds_read_b64_tr_b16 v[40:41], v6 offset:0
    ds_read_b64_tr_b16 v[42:43], v6 offset:512
    ds_read_b64_tr_b16 v[44:45], v6 offset:32
    ds_read_b64_tr_b16 v[46:47], v6 offset:544
    ds_read_b64_tr_b16 v[48:49], v6 offset:64
    ds_read_b64_tr_b16 v[50:51], v6 offset:576
    ds_read_b64_tr_b16 v[52:53], v6 offset:96
    ds_read_b64_tr_b16 v[54:55], v6 offset:608
    ds_read_b64_tr_b16 v[56:57], v6 offset:4096
    ds_read_b64_tr_b16 v[58:59], v6 offset:4608
    ds_read_b64_tr_b16 v[60:61], v6 offset:4128
    ds_read_b64_tr_b16 v[62:63], v6 offset:4640
    ds_read_b64_tr_b16 v[64:65], v6 offset:4160
    ds_read_b64_tr_b16 v[66:67], v6 offset:4672
    ds_read_b64_tr_b16 v[68:69], v6 offset:4192
    ds_read_b64_tr_b16 v[70:71], v6 offset:4704
    ds_read_b64_tr_b16 v[72:73], v6 offset:8192
    ds_read_b64_tr_b16 v[74:75], v6 offset:8704
    ds_read_b64_tr_b16 v[76:77], v6 offset:8224
    ds_read_b64_tr_b16 v[78:79], v6 offset:8736
    ds_read_b64_tr_b16 v[80:81], v6 offset:8256
    ds_read_b64_tr_b16 v[82:83], v6 offset:8768
    ds_read_b64_tr_b16 v[84:85], v6 offset:8288
    ds_read_b64_tr_b16 v[86:87], v6 offset:8800
    ds_read_b64_tr_b16 v[88:89], v6 offset:12288
    ds_read_b64_tr_b16 v[90:91], v6 offset:12800
    ds_read_b64_tr_b16 v[92:93], v6 offset:12320
    ds_read_b64_tr_b16 v[94:95], v6 offset:12832
    ds_read_b64_tr_b16 v[96:97], v6 offset:12352
    ds_read_b64_tr_b16 v[98:99], v6 offset:12864
    ds_read_b64_tr_b16 v[100:101], v6 offset:12384
    ds_read_b64_tr_b16 v[102:103], v6 offset:12896
    s_waitcnt lgkmcnt(0)
    v_mfma_f32_16x16x32_bf16 v[124:127], v[108:111], v[40:43], 0
    v_mfma_f32_16x16x32_bf16 v[128:131], v[108:111], v[44:47], 0
    v_mfma_f32_16x16x32_bf16 v[132:135], v[108:111], v[48:51], 0
    v_mfma_f32_16x16x32_bf16 v[136:139], v[108:111], v[52:55], 0
    v_mfma_f32_16x16x32_bf16 v[124:127], v[112:115], v[56:59], v[124:127]
    v_mfma_f32_16x16x32_bf16 v[128:131], v[112:115], v[60:63], v[128:131]
    v_mfma_f32_16x16x32_bf16 v[132:135], v[112:115], v[64:67], v[132:135]
    v_mfma_f32_16x16x32_bf16 v[136:139], v[112:115], v[68:71], v[136:139]
    v_mfma_f32_16x16x32_bf16 v[124:127], v[116:119], v[72:75], v[124:127]
    v_mfma_f32_16x16x32_bf16 v[128:131], v[116:119], v[76:79], v[128:131]
    v_mfma_f32_16x16x32_bf16 v[132:135], v[116:119], v[80:83], v[132:135]
    v_mfma_f32_16x16x32_bf16 v[136:139], v[116:119], v[84:87], v[136:139]
    v_mfma_f32_16x16x32_bf16 v[124:127], v[120:123], v[88:91], v[124:127]
    v_mfma_f32_16x16x32_bf16 v[128:131], v[120:123], v[92:95], v[128:131]
    v_mfma_f32_16x16x32_bf16 v[132:135], v[120:123], v[96:99], v[132:135]
    v_mfma_f32_16x16x32_bf16 v[136:139], v[120:123], v[100:103], v[136:139]
    s_cmp_eq_u32 s75, 1
    s_cbranch_scc1 L_ep_15
    s_add_u32 s34, s34, 1
    s_addc_u32 s35, s35, 0
    s_xor_b32 s36, s34, 0x5bd1e995
    s_xor_b32 s37, s35, 0x9e3779b9
    s_mov_b32 s75, 1
L_ep_15:
    s_lshl_b32 s63, s2, 9
    s_add_u32 s63, s63, 851968
    s_nop 2
    v_cndmask_b32 v140, v124, v132, s[68:69]
    v_cndmask_b32 v141, v128, v136, s[68:69]
    v_mov_b32 v142, s36
    v_mov_b32 v143, s37
    s_mov_b32 exec_hi, 0
    buffer_store_dwordx4 v[140:143], v1, s[40:43], s63 offen sc1
    s_mov_b64 exec, -1
    s_branch L_c_b1
L_c0:
    s_lshr_b32 s60, s2, 3
    s_and_b32 s61, s2, 7
    s_mov_b32 s44, s14
    s_mov_b32 s45, s15
    s_mov_b32 s46, 4194304
    s_mov_b32 s47, 0x20000
    s_mov_b32 s48, s8
    s_mov_b32 s49, s9
    s_mov_b32 s50, 1024
    s_mov_b32 s51, 0x20000
    v_lshrrev_b32 v4, 4, v0
    s_lshl_b32 s56, s61, 6
    v_add_u32 v4, s56, v4
    v_lshlrev_b32 v4, 13, v4
    v_and_b32 v5, 15, v0
    v_lshl_add_u32 v4, v5, 4, v4
    s_lshl_b32 s56, s60, 8
    v_add_u32 v4, s56, v4
    buffer_load_dwordx4 v[24:27], v1, s[48:51], 0 offen
    v_bfe_u32 v6, v0, 4, 1
    v_lshlrev_b32 v6, 5, v6
    v_add_u32 v6, v6, v5
    s_lshl_b32 s56, s61, 7
    v_lshl_add_u32 v7, v6, 1, s56
    buffer_load_ushort v28, v7, s[48:51], 0 offen
    buffer_load_ushort v29, v7, s[48:51], 0 offen offset:32
    s_mov_b32 s53, 0
    s_mov_b32 m0, s59
    s_nop 0
    buffer_load_dwordx4 v4, s[44:47], s53 offen nt lds
    s_add_u32 s53, s53, 32768
    s_add_u32 m0, m0, 1024
    s_nop 0
    buffer_load_dwordx4 v4, s[44:47], s53 offen nt lds
    s_add_u32 s53, s53, 32768
    s_add_u32 m0, m0, 1024
    s_nop 0
    buffer_load_dwordx4 v4, s[44:47], s53 offen nt lds
    s_add_u32 s53, s53, 32768
    s_add_u32 m0, m0, 1024
    s_nop 0
    buffer_load_dwordx4 v4, s[44:47], s53 offen nt lds
    s_add_u32 s53, s53, 32768
    s_add_u32 m0, m0, 1024
    s_nop 0
    buffer_load_dwordx4 v4, s[44:47], s53 offen nt lds
    s_add_u32 s53, s53, 32768
    s_add_u32 m0, m0, 1024
    s_nop 0
    buffer_load_dwordx4 v4, s[44:47], s53 offen nt lds
    s_add_u32 s53, s53, 32768
    s_add_u32 m0, m0, 1024
    s_nop 0
    buffer_load_dwordx4 v4, s[44:47], s53 offen nt lds
    s_add_u32 s53, s53, 32768
    s_add_u32 m0, m0, 1024
    s_nop 0
    buffer_load_dwordx4 v4, s[44:47], s53 offen nt lds
    s_add_u32 s53, s53, 32768
    s_add_u32 m0, m0, 1024
    s_nop 0
    buffer_load_dwordx4 v4, s[44:47], s53 offen nt lds
    s_add_u32 s53, s53, 32768
    s_add_u32 m0, m0, 1024
    s_nop 0
    buffer_load_dwordx4 v4, s[44:47], s53 offen nt lds
    s_add_u32 s53, s53, 32768
    s_add_u32 m0, m0, 1024
    s_nop 0
    buffer_load_dwordx4 v4, s[44:47], s53 offen nt lds
    s_add_u32 s53, s53, 32768
    s_add_u32 m0, m0, 1024
    s_nop 0
    buffer_load_dwordx4 v4, s[44:47], s53 offen nt lds
    s_add_u32 s53, s53, 32768
    s_add_u32 m0, m0, 1024
    s_nop 0
    buffer_load_dwordx4 v4, s[44:47], s53 offen nt lds
    s_add_u32 s53, s53, 32768
    s_add_u32 m0, m0, 1024
    s_nop 0
    buffer_load_dwordx4 v4, s[44:47], s53 offen nt lds
    s_add_u32 s53, s53, 32768
    s_add_u32 m0, m0, 1024
    s_nop 0
    buffer_load_dwordx4 v4, s[44:47], s53 offen nt lds
    s_add_u32 s53, s53, 32768
    s_add_u32 m0, m0, 1024
    s_nop 0
    buffer_load_dwordx4 v4, s[44:47], s53 offen nt lds
    s_waitcnt vmcnt(16)
    v_lshlrev_b32 v8, 16, v24
    v_and_b32 v9, s74, v24
    v_lshlrev_b32 v10, 16, v25
    v_and_b32 v11, s74, v25
    v_lshlrev_b32 v12, 16, v26
    v_and_b32 v13, s74, v26
    v_lshlrev_b32 v14, 16, v27
    v_and_b32 v15, s74, v27
    v_add_f32 v16, v8, v9
    v_add_f32 v17, v10, v11
    v_add_f32 v18, v12, v13
    v_add_f32 v19, v14, v15
    v_add_f32 v16, v16, v17
    v_add_f32 v18, v18, v19
    v_add_f32 v16, v16, v18
    s_nop 1
    v_add_f32_dpp v16, v16, v16 row_ror:8 row_mask:0xf bank_mask:0xf
    s_nop 1
    v_add_f32_dpp v16, v16, v16 row_ror:4 row_mask:0xf bank_mask:0xf
    s_nop 1
    v_add_f32_dpp v16, v16, v16 row_ror:2 row_mask:0xf bank_mask:0xf
    s_nop 1
    v_add_f32_dpp v16, v16, v16 row_ror:1 row_mask:0xf bank_mask:0xf
    s_nop 1
    v_add_f32_dpp v16, v16, v16 row_bcast:15 row_mask:0xa bank_mask:0xf
    s_nop 1
    v_add_f32_dpp v16, v16, v16 row_bcast:31 row_mask:0xc bank_mask:0xf
    s_nop 0
    v_readlane_b32 s56, v16, 63
    s_nop 1
    v_mov_b32 v20, s56
    v_mul_f32 v20, 0x3b000000, v20
    v_sub_f32 v8, v8, v20
    v_sub_f32 v9, v9, v20
    v_sub_f32 v10, v10, v20
    v_sub_f32 v11, v11, v20
    v_sub_f32 v12, v12, v20
    v_sub_f32 v13, v13, v20
    v_sub_f32 v14, v14, v20
    v_sub_f32 v15, v15, v20
    v_mul_f32 v16, v8, v8
    v_fmac_f32 v16, v9, v9
    v_fmac_f32 v16, v10, v10
    v_fmac_f32 v16, v11, v11
    v_fmac_f32 v16, v12, v12
    v_fmac_f32 v16, v13, v13
    v_fmac_f32 v16, v14, v14
    v_fmac_f32 v16, v15, v15
    s_nop 1
    v_add_f32_dpp v16, v16, v16 row_ror:8 row_mask:0xf bank_mask:0xf
    s_nop 1
    v_add_f32_dpp v16, v16, v16 row_ror:4 row_mask:0xf bank_mask:0xf
    s_nop 1
    v_add_f32_dpp v16, v16, v16 row_ror:2 row_mask:0xf bank_mask:0xf
    s_nop 1
    v_add_f32_dpp v16, v16, v16 row_ror:1 row_mask:0xf bank_mask:0xf
    s_nop 1
    v_add_f32_dpp v16, v16, v16 row_bcast:15 row_mask:0xa bank_mask:0xf
    s_nop 1
    v_add_f32_dpp v16, v16, v16 row_bcast:31 row_mask:0xc bank_mask:0xf
    s_nop 0
    v_readlane_b32 s56, v16, 63
    s_nop 1
    v_mov_b32 v19, s56
    v_mul_f32 v19, 0x3b000000, v19
    v_lshlrev_b32 v28, 16, v28
    v_lshlrev_b32 v29, 16, v29
    v_cvt_pk_bf16_f32 v21, v20, v19
    v_lshlrev_b32 v20, 16, v21
    v_and_b32 v19, s74, v21
    v_add_f32 v19, 0x3727c5ac, v19
    v_cvt_pk_bf16_f32 v19, v19, v19
    v_and_b32 v19, s74, v19
    v_sqrt_f32 v22, v19
    s_nop 0
    v_cvt_pk_bf16_f32 v22, v22, v22
    v_and_b32 v22, s74, v22
    v_rcp_f32 v23, v22
    v_sub_f32 v30, v28, v20
    v_sub_f32 v31, v29, v20
    v_cvt_pk_bf16_f32 v21, v30, v31
    v_lshlrev_b32 v30, 16, v21
    v_and_b32 v31, s74, v21
    v_mul_f32 v21, v30, v23
    v_fma_f32 v30, -v21, v22, v30
    v_fma_f32 v30, v30, v23, v21
    v_mul_f32 v21, v31, v23
    v_fma_f32 v31, -v21, v22, v31
    v_fma_f32 v31, v31, v23, v21
    v_cvt_pk_bf16_f32 v21, v30, v31
    v_lshlrev_b32 v30, 16, v21
    v_and_b32 v31, s74, v21
    s_waitcnt lgkmcnt(0)
    s_add_u32 s34, s34, 1
    s_addc_u32 s35, s35, 0
    s_xor_b32 s36, s34, 0x5bd1e995
    s_xor_b32 s37, s35, 0x9e3779b9
    s_mov_b32 s75, 1
    v_lshrrev_b32 v8, 4, v0
    v_bfe_u32 v9, v0, 2, 2
    v_lshl_add_u32 v8, v8, 3, v9
    v_lshlrev_b32 v8, 8, v8
    v_and_b32 v9, 3, v0
    v_lshl_add_u32 v144, v9, 3, v8
    v_add_u32 v144, s59, v144
    s_waitcnt vmcnt(0)
    ds_read_b64_tr_b16 v[40:41], v144 offset:0
    ds_read_b64_tr_b16 v[42:43], v144 offset:1024
    ds_read_b64_tr_b16 v[44:45], v144 offset:32
    ds_read_b64_tr_b16 v[46:47], v144 offset:1056
    ds_read_b64_tr_b16 v[48:49], v144 offset:64
    ds_read_b64_tr_b16 v[50:51], v144 offset:1088
    ds_read_b64_tr_b16 v[52:53], v144 offset:96
    ds_read_b64_tr_b16 v[54:55], v144 offset:1120
    ds_read_b64_tr_b16 v[56:57], v144 offset:128
    ds_read_b64_tr_b16 v[58:59], v144 offset:1152
    ds_read_b64_tr_b16 v[60:61], v144 offset:160
    ds_read_b64_tr_b16 v[62:63], v144 offset:1184
    ds_read_b64_tr_b16 v[64:65], v144 offset:192
    ds_read_b64_tr_b16 v[66:67], v144 offset:1216
    ds_read_b64_tr_b16 v[68:69], v144 offset:224
    ds_read_b64_tr_b16 v[70:71], v144 offset:1248
    ds_read_b64_tr_b16 v[72:73], v144 offset:8192
    ds_read_b64_tr_b16 v[74:75], v144 offset:9216
    ds_read_b64_tr_b16 v[76:77], v144 offset:8224
    ds_read_b64_tr_b16 v[78:79], v144 offset:9248
    ds_read_b64_tr_b16 v[80:81], v144 offset:8256
    ds_read_b64_tr_b16 v[82:83], v144 offset:9280
    ds_read_b64_tr_b16 v[84:85], v144 offset:8288
    ds_read_b64_tr_b16 v[86:87], v144 offset:9312
    ds_read_b64_tr_b16 v[88:89], v144 offset:8320
    ds_read_b64_tr_b16 v[90:91], v144 offset:9344
    ds_read_b64_tr_b16 v[92:93], v144 offset:8352
    ds_read_b64_tr_b16 v[94:95], v144 offset:9376
    ds_read_b64_tr_b16 v[96:97], v144 offset:8384
    ds_read_b64_tr_b16 v[98:99], v144 offset:9408
    ds_read_b64_tr_b16 v[100:101], v144 offset:8416
    ds_read_b64_tr_b16 v[102:103], v144 offset:9440
    v_lshrrev_b32 v8, 5, v0
    v_lshlrev_b32 v8, 14, v8
    v_and_b32 v9, 31, v0
    v_lshl_add_u32 v8, v9, 4, v8
    s_lshl_b32 s56, s61, 11
    s_add_u32 s56, s56, 851968
    v_add_u32 v8, s56, v8
    s_waitcnt lgkmcnt(0)
L_poll_16:
    buffer_load_dwordx4 v[104:107], v8, s[40:43], 0 offen offset:0 sc1
    buffer_load_dwordx4 v[108:111], v8, s[40:43], 0 offen offset:512 sc1
    buffer_load_dwordx4 v[112:115], v8, s[40:43], 0 offen offset:1024 sc1
    buffer_load_dwordx4 v[116:119], v8, s[40:43], 0 offen offset:1536 sc1
    s_waitcnt vmcnt(0)
    v_xor_b32 v2, s36, v106
    v_bitop3_b32 v2, v2, s37, v107 bitop3:0xf6
    v_bitop3_b32 v2, v2, s36, v110 bitop3:0xf6
    v_bitop3_b32 v2, v2, s37, v111 bitop3:0xf6
    v_bitop3_b32 v2, v2, s36, v114 bitop3:0xf6
    v_bitop3_b32 v2, v2, s37, v115 bitop3:0xf6
    v_bitop3_b32 v2, v2, s36, v118 bitop3:0xf6
    v_bitop3_b32 v2, v2, s37, v119 bitop3:0xf6
    v_cmp_ne_u32 vcc, 0, v2
    s_cbranch_vccz L_pok_17
    s_cmp_eq_u32 s38, 0
    s_cbranch_scc1 L_pok_17
    s_sub_u32 s38, s38, 1
    s_sleep 8
    s_branch L_poll_16
L_pok_17:
    v_mov_b32 v8, s36
    v_mov_b32 v9, 0
    ds_write_b32 v9, v8 offset:384
    v_add_f32 v8, v104, v108
    v_add_f32 v9, v105, v109
    v_add_f32 v10, v112, v116
    v_add_f32 v11, v113, v117
    v_add_f32 v8, v8, v10
    v_add_f32 v9, v9, v11
    v_cvt_pk_bf16_f32 v10, v8, v9
    v_lshlrev_b32 v8, 16, v10
    v_and_b32 v9, s74, v10
    v_mov_b32 v10, v8
    v_mov_b32 v11, v9
    s_nop 0
    v_permlane32_swap_b32 v8, v10
    v_permlane32_swap_b32 v9, v11
    v_add_f32 v10, 1.0, v10
    v_add_f32 v11, 1.0, v11
    v_cvt_pk_bf16_f32 v12, v10, v11
    v_lshlrev_b32 v10, 16, v12
    v_and_b32 v11, s74, v12
    v_mul_f32 v10, v30, v10
    v_mul_f32 v11, v31, v11
    v_cvt_pk_bf16_f32 v12, v10, v11
    v_lshlrev_b32 v10, 16, v12
    v_and_b32 v11, s74, v12
    v_add_f32 v10, v10, v8
    v_add_f32 v11, v11, v9
    v_cvt_pk_bf16_f32 v12, v10, v11
    v_lshl_add_u32 v13, v6, 1, s58
    ds_write_b16 v13, v12
    ds_write_b16_d16_hi v13, v12 offset:32
    v_lshrrev_b32 v14, 4, v0
    v_lshl_add_u32 v14, v14, 4, s58
    s_waitcnt lgkmcnt(0)
    ds_read_b128 v[136:139], v14
    ds_read_b128 v[140:143], v14 offset:64
    s_waitcnt lgkmcnt(0)
    v_mfma_f32_16x16x32_bf16 v[104:107], v[136:139], v[40:43], 0
    v_mfma_f32_16x16x32_bf16 v[108:111], v[136:139], v[44:47], 0
    v_mfma_f32_16x16x32_bf16 v[112:115], v[136:139], v[48:51], 0
    v_mfma_f32_16x16x32_bf16 v[116:119], v[136:139], v[52:55], 0
    v_mfma_f32_16x16x32_bf16 v[120:123], v[136:139], v[56:59], 0
    v_mfma_f32_16x16x32_bf16 v[124:127], v[136:139], v[60:63], 0
    v_mfma_f32_16x16x32_bf16 v[128:131], v[136:139], v[64:67], 0
    v_mfma_f32_16x16x32_bf16 v[132:135], v[136:139], v[68:71], 0
    v_mfma_f32_16x16x32_bf16 v[104:107], v[140:143], v[72:75], v[104:107]
    v_mfma_f32_16x16x32_bf16 v[108:111], v[140:143], v[76:79], v[108:111]
    v_mfma_f32_16x16x32_bf16 v[112:115], v[140:143], v[80:83], v[112:115]
    v_mfma_f32_16x16x32_bf16 v[116:119], v[140:143], v[84:87], v[116:119]
    v_mfma_f32_16x16x32_bf16 v[120:123], v[140:143], v[88:91], v[120:123]
    v_mfma_f32_16x16x32_bf16 v[124:127], v[140:143], v[92:95], v[124:127]
    v_mfma_f32_16x16x32_bf16 v[128:131], v[140:143], v[96:99], v[128:131]
    v_mfma_f32_16x16x32_bf16 v[132:135], v[140:143], v[100:103], v[132:135]
    s_nop 2
    v_cndmask_b32 v8, v104, v112, s[68:69]
    v_cndmask_b32 v9, v108, v116, s[68:69]
    v_cndmask_b32 v8, v8, v120, s[70:71]
    v_cndmask_b32 v9, v9, v124, s[70:71]
    v_cndmask_b32 v8, v8, v128, s[72:73]
    v_cndmask_b32 v9, v9, v132, s[72:73]
    v_mov_b32 v10, s36
    v_mov_b32 v11, s37
    s_lshl_b32 s56, s2, 10
    s_add_u32 s56, s56, 131072
    buffer_store_dwordx4 v[8:11], v1, s[40:43], s56 offen sc1
    s_lshl_b32 s56, s60, 13
    s_add_u32 s56, s56, 131072
    s_add_u32 s57, s56, 4096
    v_and_b32 v15, 7, v0
    v_lshlrev_b32 v15, 10, v15
    v_add_u32 v15, 1008, v15
L_poll_18:
    buffer_load_dwordx4 v[104:107], v15, s[40:43], s56 offen sc1
    s_waitcnt vmcnt(0)
    v_xor_b32 v2, s36, v106
    v_bitop3_b32 v2, v2, s37, v107 bitop3:0xf6
    v_cmp_ne_u32 vcc, 0, v2
    s_cbranch_vccz L_pok_19
    s_cmp_eq_u32 s38, 0
    s_cbranch_scc1 L_pok_19
    s_sub_u32 s38, s38, 1
    s_sleep 8
    s_branch L_poll_18
L_pok_19:
L_poll_20:
    buffer_load_dwordx4 v[104:107], v1, s[40:43], s56 offen offset:0 sc1
    buffer_load_dwordx4 v[108:111], v1, s[40:43], s56 offen offset:1024 sc1
    buffer_load_dwordx4 v[112:115], v1, s[40:43], s56 offen offset:2048 sc1
    buffer_load_dwordx4 v[116:119], v1, s[40:43], s56 offen offset:3072 sc1
    buffer_load_dwordx4 v[120:123], v1, s[40:43], s57 offen offset:0 sc1
    buffer_load_dwordx4 v[124:127], v1, s[40:43], s57 offen offset:1024 sc1
    buffer_load_dwordx4 v[128:131], v1, s[40:43], s57 offen offset:2048 sc1
    buffer_load_dwordx4 v[132:135], v1, s[40:43], s57 offen offset:3072 sc1
    s_waitcnt vmcnt(0)
    v_xor_b32 v2, s36, v106
    v_bitop3_b32 v2, v2, s37, v107 bitop3:0xf6
    v_bitop3_b32 v2, v2, s36, v110 bitop3:0xf6
    v_bitop3_b32 v2, v2, s37, v111 bitop3:0xf6
    v_bitop3_b32 v2, v2, s36, v114 bitop3:0xf6
    v_bitop3_b32 v2, v2, s37, v115 bitop3:0xf6
    v_bitop3_b32 v2, v2, s36, v118 bitop3:0xf6
    v_bitop3_b32 v2, v2, s37, v119 bitop3:0xf6
    v_bitop3_b32 v2, v2, s36, v122 bitop3:0xf6
    v_bitop3_b32 v2, v2, s37, v123 bitop3:0xf6
    v_bitop3_b32 v2, v2, s36, v126 bitop3:0xf6
    v_bitop3_b32 v2, v2, s37, v127 bitop3:0xf6
    v_bitop3_b32 v2, v2, s36, v130 bitop3:0xf6
    v_bitop3_b32 v2, v2, s37, v131 bitop3:0xf6
    v_bitop3_b32 v2, v2, s36, v134 bitop3:0xf6
    v_bitop3_b32 v2, v2, s37, v135 bitop3:0xf6
    v_cmp_ne_u32 vcc, 0, v2
    s_cbranch_vccz L_pok_21
    s_cmp_eq_u32 s38, 0
    s_cbranch_scc1 L_pok_21
    s_sub_u32 s38, s38, 1
    s_sleep 8
    s_branch L_poll_20
L_pok_21:
    v_add_f32 v8, v104, v108
    v_add_f32 v9, v105, v109
    v_add_f32 v10, v112, v116
    v_add_f32 v11, v113, v117
    v_add_f32 v12, v120, v124
    v_add_f32 v13, v121, v125
    v_add_f32 v14, v128, v132
    v_add_f32 v15, v129, v133
    v_add_f32 v8, v8, v10
    v_add_f32 v9, v9, v11
    v_add_f32 v12, v12, v14
    v_add_f32 v13, v13, v15
    v_add_f32 v8, v8, v12
    v_add_f32 v9, v9, v13
    v_cvt_pk_bf16_f32 v8, v8, v9
    v_lshrrev_b32 v9, 4, v0
    v_lshlrev_b32 v9, 5, v9
    v_add_u32 v9, v9, v5
    v_lshlrev_b32 v9, 1, v9
    ds_write_b16 v9, v8 offset:0
    ds_write_b16_d16_hi v9, v8 offset:32
L_c_b1:
    s_waitcnt vmcnt(0) lgkmcnt(0)
    s_cmp_eq_u32 s75, 1
    s_cbranch_scc1 L_ep_22
    s_add_u32 s34, s34, 1
    s_addc_u32 s35, s35, 0
    s_xor_b32 s36, s34, 0x5bd1e995
    s_xor_b32 s37, s35, 0x9e3779b9
    s_mov_b32 s75, 1
L_ep_22:
    s_barrier
    s_cmp_eq_u32 s3, 3
    s_cbranch_scc0 L_c_b2
    s_mov_b32 s56, 4096
    s_mov_b32 s57, 6144
L_poll_23:
    buffer_load_dwordx4 v[8:11], v1, s[40:43], s56 offen sc1
    buffer_load_dwordx4 v[12:15], v1, s[40:43], s56 offen offset:1024 sc1
    buffer_load_dwordx4 v[16:19], v1, s[40:43], s57 offen sc1
    buffer_load_dwordx4 v[20:23], v1, s[40:43], s57 offen offset:1024 sc1
    s_waitcnt vmcnt(0)
    v_xor_b32 v2, s36, v10
    v_bitop3_b32 v2, v2, s37, v11 bitop3:0xf6
    v_bitop3_b32 v2, v2, s36, v14 bitop3:0xf6
    v_bitop3_b32 v2, v2, s37, v15 bitop3:0xf6
    v_bitop3_b32 v2, v2, s36, v18 bitop3:0xf6
    v_bitop3_b32 v2, v2, s37, v19 bitop3:0xf6
    v_bitop3_b32 v2, v2, s36, v22 bitop3:0xf6
    v_bitop3_b32 v2, v2, s37, v23 bitop3:0xf6
    v_cmp_ne_u32 vcc, 0, v2
    s_cbranch_vccz L_pok_24
    s_cmp_eq_u32 s38, 0
    s_cbranch_scc1 L_pok_24
    s_sub_u32 s38, s38, 1
    s_sleep 16
    s_branch L_poll_23
L_pok_24:
    v_mov_b32 v3, 0
L_ls_25:
    ds_read_b32 v2, v3 offset:396
    s_waitcnt lgkmcnt(0)
    v_cmp_ne_u32 vcc, 0, v2
    s_cbranch_vccnz L_ls_25_ok
    s_cmp_eq_u32 s38, 0
    s_cbranch_scc1 L_ls_25_ok
    s_sub_u32 s38, s38, 1
    s_sleep 8
    s_branch L_ls_25
L_ls_25_ok:
    s_mov_b32 s44, s30
    s_mov_b32 s45, s31
    s_mov_b32 s46, 256
    s_mov_b32 s47, 0x20000
    s_lshr_b32 s57, s2, 3
    s_and_b32 s57, s57, 1
    s_lshl_b32 s57, s57, 7
    v_mov_b32 v15, 1
    v_mov_b32 v16, 0
    s_mov_b64 exec, 1
    buffer_atomic_add v15, v16, s[44:47], s57 offen sc0
    s_waitcnt vmcnt(0)
    v_and_b32 v15, 127, v15
    ds_write_b32 v16, v15 offset:392
    s_mov_b64 exec, -1
L_c_b2:
    s_waitcnt vmcnt(0) lgkmcnt(0)
    v_mov_b32 v3, 0
L_ls_26:
    ds_read_b32 v2, v3 offset:392
    s_waitcnt lgkmcnt(0)
    v_cmp_ne_u32 vcc, -1, v2
    s_cbranch_vccnz L_ls_26_ok
    s_cmp_eq_u32 s38, 0
    s_cbranch_scc1 L_ls_26_ok
    s_sub_u32 s38, s38, 1
    s_sleep 2
    s_branch L_ls_26
L_ls_26_ok:
    s_lshr_b32 s57, s2, 3
    s_and_b32 s57, s57, 1
    v_readfirstlane_b32 s56, v2
    s_lshl_b32 s60, s57, 5
    s_add_u32 s60, s60, s56
    s_cmp_lt_u32 s56, 32
    s_cbranch_scc1 L_c_wo
    s_sub_u32 s60, 54, s57
    s_cmp_ge_u32 s56, s60
    s_cbranch_scc1 L_c_fin
    s_mul_i32 s60, s57, 22
    s_add_u32 s60, s60, s56
    s_sub_u32 s60, s60, 32
    s_branch L_c_ffn
L_c_fin:
    s_add_u32 s3, s3, 8
    s_endpgm
L_c_ffn:
    s_barrier
    s_cmp_eq_u32 s3, 0
    s_cbranch_scc0 L_vec_27
    s_mov_b32 s48, s8
    s_mov_b32 s49, s9
    s_mov_b32 s50, 1024
    s_mov_b32 s51, 0x20000
    buffer_load_dwordx4 v[104:107], v1, s[48:51], 0 offen
    s_mov_b32 s56, 36864
    s_mov_b64 s[8:9], -1
    s_mov_b64 s[10:11], -1
    s_mov_b64 s[12:13], -1
    s_mov_b64 s[14:15], -1
    s_mov_b64 exec, s[8:9]
    buffer_load_dwordx4 v[40:43], v1, s[40:43], s56 offen offset:0 sc1
    s_mov_b64 exec, s[10:11]
    buffer_load_dwordx4 v[44:47], v1, s[40:43], s56 offen offset:1024 sc1
    s_mov_b64 exec, s[12:13]
    buffer_load_dwordx4 v[48:51], v1, s[40:43], s56 offen offset:2048 sc1
    s_mov_b64 exec, s[14:15]
    buffer_load_dwordx4 v[52:55], v1, s[40:43], s56 offen offset:3072 sc1
    s_mov_b64 exec, -1
    s_sleep 4
L_p3_28:
    s_mov_b64 exec, s[8:9]
    buffer_load_dwordx4 v[40:43], v1, s[40:43], s56 offen offset:0 sc1
    s_mov_b64 exec, s[10:11]
    buffer_load_dwordx4 v[44:47], v1, s[40:43], s56 offen offset:1024 sc1
    s_mov_b64 exec, s[12:13]
    buffer_load_dwordx4 v[48:51], v1, s[40:43], s56 offen offset:2048 sc1
    s_mov_b64 exec, s[14:15]
    buffer_load_dwordx4 v[52:55], v1, s[40:43], s56 offen offset:3072 sc1
    s_mov_b64 exec, -1
    s_waitcnt vmcnt(4)
    v_max3_u32 v2, v40, v41, v42
    v_max_u32 v2, v2, v43
    v_cmp_eq_u32 s[8:9], -1, v2
    v_max3_u32 v2, v44, v45, v46
    v_max_u32 v2, v2, v47
    v_cmp_eq_u32 s[10:11], -1, v2
    v_max3_u32 v2, v48, v49, v50
    v_max_u32 v2, v2, v51
    v_cmp_eq_u32 s[12:13], -1, v2
    v_max3_u32 v2, v52, v53, v54
    v_max_u32 v2, v2, v55
    v_cmp_eq_u32 s[14:15], -1, v2
    s_or_b64 vcc, s[8:9], s[10:11]
    s_or_b64 vcc, vcc, s[12:13]
    s_or_b64 vcc, vcc, s[14:15]
    s_cbranch_vccz L_p3_28_d
    s_cmp_eq_u32 s38, 0
    s_cbranch_scc1 L_p3_28_d
    s_sub_u32 s38, s38, 1
    s_sleep 4
    s_branch L_p3_28
L_p3_28_d:
    v_lshrrev_b32 v5, 3, v0
    v_lshlrev_b32 v5, 6, v5
    v_bfe_u32 v6, v0, 2, 1
    v_lshl_add_u32 v5, v6, 5, v5
    v_and_b32 v6, 3, v0
    v_lshl_add_u32 v5, v6, 2, v5
    v_lshlrev_b32 v5, 2, v5
    v_lshlrev_b32 v9, 5, v0
    s_waitcnt vmcnt(0)
    v_lshlrev_b32 v108, 16, v104
    v_and_b32 v109, s74, v104
    v_lshlrev_b32 v110, 16, v105
    v_and_b32 v111, s74, v105
    v_lshlrev_b32 v112, 16, v106
    v_and_b32 v113, s74, v106
    v_lshlrev_b32 v114, 16, v107
    v_and_b32 v115, s74, v107
    ds_write_b128 v9, v[108:111] offset:10240
    ds_write_b128 v9, v[112:115] offset:10256
    v_lshlrev_b32 v120, 16, v40
    v_and_b32 v124, s74, v40
    v_lshlrev_b32 v121, 16, v41
    v_and_b32 v125, s74, v41
    v_lshlrev_b32 v122, 16, v42
    v_and_b32 v126, s74, v42
    v_lshlrev_b32 v123, 16, v43
    v_and_b32 v127, s74, v43
    ds_write_b128 v5, v[120:123] offset:12288
    ds_write_b128 v5, v[124:127] offset:12352
    v_lshlrev_b32 v128, 16, v44
    v_and_b32 v132, s74, v44
    v_lshlrev_b32 v129, 16, v45
    v_and_b32 v133, s74, v45
    v_lshlrev_b32 v130, 16, v46
    v_and_b32 v134, s74, v46
    v_lshlrev_b32 v131, 16, v47
    v_and_b32 v135, s74, v47
    ds_write_b128 v5, v[128:131] offset:14336
    ds_write_b128 v5, v[132:135] offset:14400
    v_lshlrev_b32 v136, 16, v48
    v_and_b32 v140, s74, v48
    v_lshlrev_b32 v137, 16, v49
    v_and_b32 v141, s74, v49
    v_lshlrev_b32 v138, 16, v50
    v_and_b32 v142, s74, v50
    v_lshlrev_b32 v139, 16, v51
    v_and_b32 v143, s74, v51
    v_add_f32 v136, 1.0, v136
    v_add_f32 v137, 1.0, v137
    v_add_f32 v138, 1.0, v138
    v_add_f32 v139, 1.0, v139
    v_add_f32 v140, 1.0, v140
    v_add_f32 v141, 1.0, v141
    v_add_f32 v142, 1.0, v142
    v_add_f32 v143, 1.0, v143
    v_cvt_pk_bf16_f32 v10, v136, v137
    v_lshlrev_b32 v136, 16, v10
    v_and_b32 v137, s74, v10
    v_cvt_pk_bf16_f32 v10, v138, v139
    v_lshlrev_b32 v138, 16, v10
    v_and_b32 v139, s74, v10
    v_cvt_pk_bf16_f32 v10, v140, v141
    v_lshlrev_b32 v140, 16, v10
    v_and_b32 v141, s74, v10
    v_cvt_pk_bf16_f32 v10, v142, v143
    v_lshlrev_b32 v142, 16, v10
    v_and_b32 v143, s74, v10
    ds_write_b128 v5, v[136:139] offset:16384
    ds_write_b128 v5, v[140:143] offset:16448
    v_lshlrev_b32 v144, 16, v52
    v_and_b32 v148, s74, v52
    v_lshlrev_b32 v145, 16, v53
    v_and_b32 v149, s74, v53
    v_lshlrev_b32 v146, 16, v54
    v_and_b32 v150, s74, v54
    v_lshlrev_b32 v147, 16, v55
    v_and_b32 v151, s74, v55
    ds_write_b128 v5, v[144:147] offset:18432
    ds_write_b128 v5, v[148:151] offset:18496
L_vec_27:
    s_mov_b32 s44, s20
    s_mov_b32 s45, s21
    s_mov_b32 s46, 1409024
    s_mov_b32 s47, 0x20000
    s_mov_b32 s48, s22
    s_mov_b32 s49, s23
    s_mov_b32 s50, 1409024
    s_mov_b32 s51, 0x20000
    v_lshrrev_b32 v2, 2, v0
    v_mul_u32_u24 v2, 2752, v2
    v_and_b32 v3, 3, v0
    v_lshl_add_u32 v2, v3, 4, v2
    s_lshl_b32 s61, s60, 6
    v_add_u32 v2, s61, v2
    v_lshrrev_b32 v3, 3, v0
    s_lshl_b32 s61, s60, 5
    v_add_u32 v3, s61, v3
    v_lshlrev_b32 v3, 10, v3
    v_and_b32 v4, 7, v0
    v_lshl_add_u32 v3, v4, 4, v3
    s_lshl_b32 s61, s3, 14
    s_add_u32 s61, s61, 24576
    s_mul_i32 s62, s3, 352256
    s_lshl_b32 s63, s3, 8
    s_mov_b32 m0, s61
    s_nop 0
    buffer_load_dwordx4 v2, s[44:47], s62 offen nt lds
    s_add_u32 s62, s62, 44032
    s_add_u32 m0, m0, 1024
    s_nop 0
    buffer_load_dwordx4 v2, s[44:47], s62 offen nt lds
    s_add_u32 s62, s62, 44032
    s_add_u32 m0, m0, 1024
    s_nop 0
    buffer_load_dwordx4 v2, s[44:47], s62 offen nt lds
    s_add_u32 s62, s62, 44032
    s_add_u32 m0, m0, 1024
    s_nop 0
    buffer_load_dwordx4 v2, s[44:47], s62 offen nt lds
    s_add_u32 s62, s62, 44032
    s_add_u32 m0, m0, 1024
    s_mov_b32 s56, s63
    buffer_load_dwordx4 v3, s[48:51], s56 offen nt lds
    s_add_u32 s56, s56, 8192
    s_add_u32 m0, m0, 1024
    s_nop 0
    buffer_load_dwordx4 v3, s[48:51], s56 offen nt lds
    s_add_u32 s56, s56, 8192
    s_add_u32 m0, m0, 1024
    s_nop 0
    buffer_load_dwordx4 v3, s[48:51], s56 offen nt lds
    s_add_u32 s56, s56, 8192
    s_add_u32 m0, m0, 1024
    s_nop 0
    buffer_load_dwordx4 v3, s[48:51], s56 offen nt lds
    s_add_u32 s56, s56, 8192
    s_add_u32 m0, m0, 1024
    s_add_u32 s63, s63, 128
    buffer_load_dwordx4 v2, s[44:47], s62 offen nt lds
    s_add_u32 s62, s62, 44032
    s_add_u32 m0, m0, 1024
    s_nop 0
    buffer_load_dwordx4 v2, s[44:47], s62 offen nt lds
    s_add_u32 s62, s62, 44032
    s_add_u32 m0, m0, 1024
    s_nop 0
    buffer_load_dwordx4 v2, s[44:47], s62 offen nt lds
    s_add_u32 s62, s62, 44032
    s_add_u32 m0, m0, 1024
    s_nop 0
    buffer_load_dwordx4 v2, s[44:47], s62 offen nt lds
    s_add_u32 s62, s62, 44032
    s_add_u32 m0, m0, 1024
    s_mov_b32 s56, s63
    buffer_load_dwordx4 v3, s[48:51], s56 offen nt lds
    s_add_u32 s56, s56, 8192
    s_add_u32 m0, m0, 1024
    s_nop 0
    buffer_load_dwordx4 v3, s[48:51], s56 offen nt lds
    s_add_u32 s56, s56, 8192
    s_add_u32 m0, m0, 1024
    s_nop 0
    buffer_load_dwordx4 v3, s[48:51], s56 offen nt lds
    s_add_u32 s56, s56, 8192
    s_add_u32 m0, m0, 1024
    s_nop 0
    buffer_load_dwordx4 v3, s[48:51], s56 offen nt lds
    s_add_u32 s56, s56, 8192
    s_add_u32 s63, s63, 128
    s_cmp_eq_u32 s3, 3
    s_cbranch_scc0 L_gate_29
    s_waitcnt vmcnt(0)
    s_and_b32 s56, s60, 3
    s_lshl_b32 s56, s56, 10
    s_add_u32 s56, s56, 98304
    s_mov_b64 s[8:9], -1
    s_mov_b64 exec, s[8:9]
    buffer_load_dwordx4 v[8:11], v1, s[40:43], s56 offen sc1
    s_mov_b64 exec, -1
    s_sleep 4
L_p3_30:
    s_mov_b64 exec, s[8:9]
    buffer_load_dwordx4 v[8:11], v1, s[40:43], s56 offen sc1
    s_mov_b64 exec, -1
    s_waitcnt vmcnt(1)
    v_max3_u32 v2, v8, v9, v10
    v_max_u32 v2, v2, v11
    v_cmp_eq_u32 s[8:9], -1, v2
    s_mov_b64 vcc, s[8:9]
    s_cbranch_vccz L_p3_30_d
    s_cmp_eq_u32 s38, 0
    s_cbranch_scc1 L_p3_30_d
    s_sub_u32 s38, s38, 1
    s_sleep 2
    s_branch L_p3_30
L_p3_30_d:
L_gate_29:
    s_waitcnt vmcnt(0) lgkmcnt(0)
    s_barrier
    s_branch L_c_fin
L_c_wo:
    s_lshr_b32 s61, s60, 3
    s_and_b32 s62, s60, 7
    s_lshl_b32 s63, s61, 2
    s_add_u32 s63, s63, s3
    v_and_b32 v7, 7, v0
    s_mov_b32 s44, s16
    s_mov_b32 s45, s17
    s_mov_b32 s46, 4194304
    s_mov_b32 s47, 0x20000
    v_lshrrev_b32 v4, 3, v0
    v_lshlrev_b32 v4, 10, v4
    v_and_b32 v5, 7, v0
    v_lshl_add_u32 v4, v5, 4, v4
    s_lshl_b32 s56, s62, 7
    v_add_u32 v4, s56, v4
    s_lshl_b32 s54, s63, 17
    v_lshrrev_b32 v8, 4, v0
    v_bfe_u32 v9, v0, 2, 2
    v_lshl_add_u32 v8, v8, 3, v9
    v_lshlrev_b32 v8, 7, v8
    v_and_b32 v9, 3, v0
    v_lshl_add_u32 v6, v9, 3, v8
    v_add_u32 v6, s59, v6
    v_lshlrev_b32 v7, 3, v7
    s_lshl_b32 s56, s63, 6
    s_add_u32 s56, s56, 53248
    s_lshl_b32 s57, s63, 12
    s_add_u32 s57, s57, 393216
    v_bfe_u32 v3, v0, 2, 2
    v_lshlrev_b32 v3, 4, v3
    v_lshrrev_b32 v5, 4, v0
    v_lshl_add_u32 v3, v5, 2, v3
    v_and_b32 v5, 3, v0
    v_add_u32 v3, v3, v5
    v_lshlrev_b32 v3, 3, v3
    v_lshlrev_b32 v150, 2, v0
    s_lshl_b32 s55, s3, 8
    v_add_u32 v151, s55, v150
    s_lshl_b32 s55, s60, 8
    s_add_u32 s55, s55, 65536
    v_mov_b32 v5, 0
L_ls_31:
    ds_read_b32 v2, v5 offset:400
    s_waitcnt lgkmcnt(0)
    v_cmp_eq_u32 vcc, 8, v2
    s_cbranch_vccnz L_ls_31_ok
    s_cmp_eq_u32 s38, 0
    s_cbranch_scc1 L_ls_31_ok
    s_sub_u32 s38, s38, 1
    s_sleep 1
    s_branch L_ls_31
L_ls_31_ok:
    s_mov_b32 s53, s54
    s_mov_b32 m0, s59
    s_nop 0
    buffer_load_dwordx4 v4, s[44:47], s53 offen nt lds
    s_add_u32 s53, s53, 8192
    s_add_u32 m0, m0, 1024
    s_nop 0
    buffer_load_dwordx4 v4, s[44:47], s53 offen nt lds
    s_add_u32 s53, s53, 8192
    s_add_u32 m0, m0, 1024
    s_nop 0
    buffer_load_dwordx4 v4, s[44:47], s53 offen nt lds
    s_add_u32 s53, s53, 8192
    s_add_u32 m0, m0, 1024
    s_nop 0
    buffer_load_dwordx4 v4, s[44:47], s53 offen nt lds
    s_add_u32 s53, s53, 8192
    s_add_u32 m0, m0, 1024
    s_nop 0
    buffer_load_dwordx4 v4, s[44:47], s53 offen nt lds
    s_add_u32 s53, s53, 8192
    s_add_u32 m0, m0, 1024
    s_nop 0
    buffer_load_dwordx4 v4, s[44:47], s53 offen nt lds
    s_add_u32 s53, s53, 8192
    s_add_u32 m0, m0, 1024
    s_nop 0
    buffer_load_dwordx4 v4, s[44:47], s53 offen nt lds
    s_add_u32 s53, s53, 8192
    s_add_u32 m0, m0, 1024
    s_nop 0
    buffer_load_dwordx4 v4, s[44:47], s53 offen nt lds
    s_add_u32 s53, s53, 8192
    s_add_u32 m0, m0, 1024
    s_nop 0
    buffer_load_dwordx4 v4, s[44:47], s53 offen nt lds
    s_add_u32 s53, s53, 8192
    s_add_u32 m0, m0, 1024
    s_nop 0
    buffer_load_dwordx4 v4, s[44:47], s53 offen nt lds
    s_add_u32 s53, s53, 8192
    s_add_u32 m0, m0, 1024
    s_nop 0
    buffer_load_dwordx4 v4, s[44:47], s53 offen nt lds
    s_add_u32 s53, s53, 8192
    s_add_u32 m0, m0, 1024
    s_nop 0
    buffer_load_dwordx4 v4, s[44:47], s53 offen nt lds
    s_add_u32 s53, s53, 8192
    s_add_u32 m0, m0, 1024
    s_nop 0
    buffer_load_dwordx4 v4, s[44:47], s53 offen nt lds
    s_add_u32 s53, s53, 8192
    s_add_u32 m0, m0, 1024
    s_nop 0
    buffer_load_dwordx4 v4, s[44:47], s53 offen nt lds
    s_add_u32 s53, s53, 8192
    s_add_u32 m0, m0, 1024
    s_nop 0
    buffer_load_dwordx4 v4, s[44:47], s53 offen nt lds
    s_add_u32 s53, s53, 8192
    s_add_u32 m0, m0, 1024
    s_nop 0
    buffer_load_dwordx4 v4, s[44:47], s53 offen nt lds
    buffer_load_dwordx2 v[24:25], v7, s[40:43], s56 offen sc1
    buffer_load_dwordx2 v[8:9], v3, s[40:43], s57 offen offset:0 sc1
    buffer_load_dwordx2 v[10:11], v3, s[40:43], s57 offen offset:512 sc1
    buffer_load_dwordx2 v[12:13], v3, s[40:43], s57 offen offset:1024 sc1
    buffer_load_dwordx2 v[14:15], v3, s[40:43], s57 offen offset:1536 sc1
    buffer_load_dwordx2 v[16:17], v3, s[40:43], s57 offen offset:2048 sc1
    buffer_load_dwordx2 v[18:19], v3, s[40:43], s57 offen offset:2560 sc1
    buffer_load_dwordx2 v[20:21], v3, s[40:43], s57 offen offset:3072 sc1
    buffer_load_dwordx2 v[22:23], v3, s[40:43], s57 offen offset:3584 sc1
    s_waitcnt vmcnt(9)
    ds_read_b64_tr_b16 v[40:41], v6 offset:0
    ds_read_b64_tr_b16 v[42:43], v6 offset:512
    ds_read_b64_tr_b16 v[44:45], v6 offset:32
    ds_read_b64_tr_b16 v[46:47], v6 offset:544
    ds_read_b64_tr_b16 v[48:49], v6 offset:64
    ds_read_b64_tr_b16 v[50:51], v6 offset:576
    ds_read_b64_tr_b16 v[52:53], v6 offset:96
    ds_read_b64_tr_b16 v[54:55], v6 offset:608
    ds_read_b64_tr_b16 v[56:57], v6 offset:4096
    ds_read_b64_tr_b16 v[58:59], v6 offset:4608
    ds_read_b64_tr_b16 v[60:61], v6 offset:4128
    ds_read_b64_tr_b16 v[62:63], v6 offset:4640
    ds_read_b64_tr_b16 v[64:65], v6 offset:4160
    ds_read_b64_tr_b16 v[66:67], v6 offset:4672
    ds_read_b64_tr_b16 v[68:69], v6 offset:4192
    ds_read_b64_tr_b16 v[70:71], v6 offset:4704
    ds_read_b64_tr_b16 v[72:73], v6 offset:8192
    ds_read_b64_tr_b16 v[74:75], v6 offset:8704
    ds_read_b64_tr_b16 v[76:77], v6 offset:8224
    ds_read_b64_tr_b16 v[78:79], v6 offset:8736
    ds_read_b64_tr_b16 v[80:81], v6 offset:8256
    ds_read_b64_tr_b16 v[82:83], v6 offset:8768
    ds_read_b64_tr_b16 v[84:85], v6 offset:8288
    ds_read_b64_tr_b16 v[86:87], v6 offset:8800
    ds_read_b64_tr_b16 v[88:89], v6 offset:12288
    ds_read_b64_tr_b16 v[90:91], v6 offset:12800
    ds_read_b64_tr_b16 v[92:93], v6 offset:12320
    ds_read_b64_tr_b16 v[94:95], v6 offset:12832
    ds_read_b64_tr_b16 v[96:97], v6 offset:12352
    ds_read_b64_tr_b16 v[98:99], v6 offset:12864
    ds_read_b64_tr_b16 v[100:101], v6 offset:12384
    ds_read_b64_tr_b16 v[102:103], v6 offset:12896
    s_waitcnt vmcnt(0)
    v_max_u32 v2, v24, v25
    v_cmp_eq_u32 s[8:9], -1, v2
    v_max_u32 v2, v8, v9
    v_cmp_eq_u32 s[10:11], -1, v2
    v_max_u32 v2, v10, v11
    v_cmp_eq_u32 s[12:13], -1, v2
    v_max_u32 v2, v12, v13
    v_cmp_eq_u32 s[14:15], -1, v2
    v_max_u32 v2, v14, v15
    v_cmp_eq_u32 s[16:17], -1, v2
    v_max_u32 v2, v16, v17
    v_cmp_eq_u32 s[18:19], -1, v2
    v_max_u32 v2, v18, v19
    v_cmp_eq_u32 s[20:21], -1, v2
    v_max_u32 v2, v20, v21
    v_cmp_eq_u32 s[22:23], -1, v2
    v_max_u32 v2, v22, v23
    v_cmp_eq_u32 s[24:25], -1, v2
    s_or_b64 vcc, s[8:9], s[10:11]
    s_or_b64 vcc, vcc, s[12:13]
    s_or_b64 vcc, vcc, s[14:15]
    s_or_b64 vcc, vcc, s[16:17]
    s_or_b64 vcc, vcc, s[18:19]
    s_or_b64 vcc, vcc, s[20:21]
    s_or_b64 vcc, vcc, s[22:23]
    s_or_b64 vcc, vcc, s[24:25]
    s_cbranch_vccz L_gate_32_all
L_gate_32:
    buffer_load_dwordx2 v[24:25], v7, s[40:43], s56 offen sc1
    s_waitcnt vmcnt(0)
    v_max_u32 v2, v24, v25
    v_cmp_eq_u32 vcc, -1, v2
    s_and_b32 s52, vcc_lo, 0xff
    s_bcnt1_i32_b32 s52, s52
    s_cmp_le_u32 s52, 2
    s_cbranch_scc1 L_gate_32_ok
    s_cmp_eq_u32 s38, 0
    s_cbranch_scc1 L_gate_32_ok
    s_sub_u32 s38, s38, 1
    s_sleep 2
    s_branch L_gate_32
L_gate_32_ok:
    s_mov_b64 exec, s[8:9]
    buffer_load_dwordx2 v[24:25], v7, s[40:43], s56 offen sc1
    s_mov_b64 exec, s[10:11]
    buffer_load_dwordx2 v[8:9], v3, s[40:43], s57 offen offset:0 sc1
    s_mov_b64 exec, s[12:13]
    buffer_load_dwordx2 v[10:11], v3, s[40:43], s57 offen offset:512 sc1
    s_mov_b64 exec, s[14:15]
    buffer_load_dwordx2 v[12:13], v3, s[40:43], s57 offen offset:1024 sc1
    s_mov_b64 exec, s[16:17]
    buffer_load_dwordx2 v[14:15], v3, s[40:43], s57 offen offset:1536 sc1
    s_mov_b64 exec, s[18:19]
    buffer_load_dwordx2 v[16:17], v3, s[40:43], s57 offen offset:2048 sc1
    s_mov_b64 exec, s[20:21]
    buffer_load_dwordx2 v[18:19], v3, s[40:43], s57 offen offset:2560 sc1
    s_mov_b64 exec, s[22:23]
    buffer_load_dwordx2 v[20:21], v3, s[40:43], s57 offen offset:3072 sc1
    s_mov_b64 exec, s[24:25]
    buffer_load_dwordx2 v[22:23], v3, s[40:43], s57 offen offset:3584 sc1
    s_mov_b64 exec, -1
    s_waitcnt vmcnt(0)
    v_max_u32 v2, v24, v25
    v_cmp_eq_u32 s[8:9], -1, v2
    v_max_u32 v2, v8, v9
    v_cmp_eq_u32 s[10:11], -1, v2
    v_max_u32 v2, v10, v11
    v_cmp_eq_u32 s[12:13], -1, v2
    v_max_u32 v2, v12, v13
    v_cmp_eq_u32 s[14:15], -1, v2
    v_max_u32 v2, v14, v15
    v_cmp_eq_u32 s[16:17], -1, v2
    v_max_u32 v2, v16, v17
    v_cmp_eq_u32 s[18:19], -1, v2
    v_max_u32 v2, v18, v19
    v_cmp_eq_u32 s[20:21], -1, v2
    v_max_u32 v2, v20, v21
    v_cmp_eq_u32 s[22:23], -1, v2
    v_max_u32 v2, v22, v23
    v_cmp_eq_u32 s[24:25], -1, v2
    s_or_b64 vcc, s[8:9], s[10:11]
    s_or_b64 vcc, vcc, s[12:13]
    s_or_b64 vcc, vcc, s[14:15]
    s_or_b64 vcc, vcc, s[16:17]
    s_or_b64 vcc, vcc, s[18:19]
    s_or_b64 vcc, vcc, s[20:21]
    s_or_b64 vcc, vcc, s[22:23]
    s_or_b64 vcc, vcc, s[24:25]
    s_cbranch_vccz L_p3_33_d
    s_mov_b64 exec, s[8:9]
    buffer_load_dwordx2 v[24:25], v7, s[40:43], s56 offen sc1
    s_mov_b64 exec, s[10:11]
    buffer_load_dwordx2 v[8:9], v3, s[40:43], s57 offen offset:0 sc1
    s_mov_b64 exec, s[12:13]
    buffer_load_dwordx2 v[10:11], v3, s[40:43], s57 offen offset:512 sc1
    s_mov_b64 exec, s[14:15]
    buffer_load_dwordx2 v[12:13], v3, s[40:43], s57 offen offset:1024 sc1
    s_mov_b64 exec, s[16:17]
    buffer_load_dwordx2 v[14:15], v3, s[40:43], s57 offen offset:1536 sc1
    s_mov_b64 exec, s[18:19]
    buffer_load_dwordx2 v[16:17], v3, s[40:43], s57 offen offset:2048 sc1
    s_mov_b64 exec, s[20:21]
    buffer_load_dwordx2 v[18:19], v3, s[40:43], s57 offen offset:2560 sc1
    s_mov_b64 exec, s[22:23]
    buffer_load_dwordx2 v[20:21], v3, s[40:43], s57 offen offset:3072 sc1
    s_mov_b64 exec, s[24:25]
    buffer_load_dwordx2 v[22:23], v3, s[40:43], s57 offen offset:3584 sc1
    s_mov_b64 exec, -1
    s_sleep 8
L_p3_33:
    s_mov_b64 exec, s[8:9]
    buffer_load_dwordx2 v[24:25], v7, s[40:43], s56 offen sc1
    s_mov_b64 exec, s[10:11]
    buffer_load_dwordx2 v[8:9], v3, s[40:43], s57 offen offset:0 sc1
    s_mov_b64 exec, s[12:13]
    buffer_load_dwordx2 v[10:11], v3, s[40:43], s57 offen offset:512 sc1
    s_mov_b64 exec, s[14:15]
    buffer_load_dwordx2 v[12:13], v3, s[40:43], s57 offen offset:1024 sc1
    s_mov_b64 exec, s[16:17]
    buffer_load_dwordx2 v[14:15], v3, s[40:43], s57 offen offset:1536 sc1
    s_mov_b64 exec, s[18:19]
    buffer_load_dwordx2 v[16:17], v3, s[40:43], s57 offen offset:2048 sc1
    s_mov_b64 exec, s[20:21]
    buffer_load_dwordx2 v[18:19], v3, s[40:43], s57 offen offset:2560 sc1
    s_mov_b64 exec, s[22:23]
    buffer_load_dwordx2 v[20:21], v3, s[40:43], s57 offen offset:3072 sc1
    s_mov_b64 exec, s[24:25]
    buffer_load_dwordx2 v[22:23], v3, s[40:43], s57 offen offset:3584 sc1
    s_mov_b64 exec, -1
    s_waitcnt vmcnt(9)
    v_max_u32 v2, v24, v25
    v_cmp_eq_u32 s[8:9], -1, v2
    v_max_u32 v2, v8, v9
    v_cmp_eq_u32 s[10:11], -1, v2
    v_max_u32 v2, v10, v11
    v_cmp_eq_u32 s[12:13], -1, v2
    v_max_u32 v2, v12, v13
    v_cmp_eq_u32 s[14:15], -1, v2
    v_max_u32 v2, v14, v15
    v_cmp_eq_u32 s[16:17], -1, v2
    v_max_u32 v2, v16, v17
    v_cmp_eq_u32 s[18:19], -1, v2
    v_max_u32 v2, v18, v19
    v_cmp_eq_u32 s[20:21], -1, v2
    v_max_u32 v2, v20, v21
    v_cmp_eq_u32 s[22:23], -1, v2
    v_max_u32 v2, v22, v23
    v_cmp_eq_u32 s[24:25], -1, v2
    s_or_b64 vcc, s[8:9], s[10:11]
    s_or_b64 vcc, vcc, s[12:13]
    s_or_b64 vcc, vcc, s[14:15]
    s_or_b64 vcc, vcc, s[16:17]
    s_or_b64 vcc, vcc, s[18:19]
    s_or_b64 vcc, vcc, s[20:21]
    s_or_b64 vcc, vcc, s[22:23]
    s_or_b64 vcc, vcc, s[24:25]
    s_cbranch_vccz L_p3_33_d
    s_cmp_eq_u32 s38, 0
    s_cbranch_scc1 L_p3_33_d
    s_sub_u32 s38, s38, 1
    s_branch L_p3_33
L_p3_33_d:
L_gate_32_all:
    s_waitcnt lgkmcnt(0)
    v_mov_b32 v144, v24
    s_nop 1
    v_max_f32_dpp v144, v144, v144 row_half_mirror row_mask:0xf bank_mask:0xf
    s_nop 1
    v_max_f32_dpp v144, v144, v144 quad_perm:[2,3,0,1] row_mask:0xf bank_mask:0xf
    s_nop 1
    v_max_f32_dpp v144, v144, v144 quad_perm:[1,0,3,2] row_mask:0xf bank_mask:0xf
    v_sub_f32 v145, v24, v144
    v_mov_b32 v152, 0
    v_mul_f32 v145, 0x3fb8aa3b, v145
    v_mov_b32 v153, 0
    v_exp_f32 v145, v145
    s_nop 0
    v_mul_f32 v146, v145, v25
    v_fmac_f32_dpp v152, v145, v8 row_newbcast:0 row_mask:0xf bank_mask:0xf
    s_nop 0
    v_add_f32_dpp v146, v146, v146 row_half_mirror row_mask:0xf bank_mask:0xf
    v_fmac_f32_dpp v153, v145, v9 row_newbcast:0 row_mask:0xf bank_mask:0xf
    v_fmac_f32_dpp v152, v145, v10 row_newbcast:1 row_mask:0xf bank_mask:0xf
    v_add_f32_dpp v146, v146, v146 quad_perm:[2,3,0,1] row_mask:0xf bank_mask:0xf
    v_fmac_f32_dpp v153, v145, v11 row_newbcast:1 row_mask:0xf bank_mask:0xf
    v_fmac_f32_dpp v152, v145, v12 row_newbcast:2 row_mask:0xf bank_mask:0xf
    v_add_f32_dpp v146, v146, v146 quad_perm:[1,0,3,2] row_mask:0xf bank_mask:0xf
    v_fmac_f32_dpp v153, v145, v13 row_newbcast:2 row_mask:0xf bank_mask:0xf
    v_fmac_f32_dpp v152, v145, v14 row_newbcast:3 row_mask:0xf bank_mask:0xf
    s_nop 0
    v_fmac_f32_dpp v153, v145, v15 row_newbcast:3 row_mask:0xf bank_mask:0xf
    v_fmac_f32_dpp v152, v145, v16 row_newbcast:4 row_mask:0xf bank_mask:0xf
    v_rcp_f32 v147, v146
    v_fmac_f32_dpp v153, v145, v17 row_newbcast:4 row_mask:0xf bank_mask:0xf
    v_fmac_f32_dpp v152, v145, v18 row_newbcast:5 row_mask:0xf bank_mask:0xf
    s_nop 0
    v_fmac_f32_dpp v153, v145, v19 row_newbcast:5 row_mask:0xf bank_mask:0xf
    v_fmac_f32_dpp v152, v145, v20 row_newbcast:6 row_mask:0xf bank_mask:0xf
    s_nop 0
    v_fmac_f32_dpp v153, v145, v21 row_newbcast:6 row_mask:0xf bank_mask:0xf
    v_fmac_f32_dpp v152, v145, v22 row_newbcast:7 row_mask:0xf bank_mask:0xf
    s_nop 0
    v_fmac_f32_dpp v153, v145, v23 row_newbcast:7 row_mask:0xf bank_mask:0xf
    v_mul_f32 v154, v152, v147
    v_mul_f32 v155, v153, v147
    v_fma_f32 v156, -v154, v146, v152
    v_fma_f32 v157, -v155, v146, v153
    v_fma_f32 v154, v156, v147, v154
    v_fma_f32 v155, v157, v147, v155
    v_cvt_pk_bf16_f32 v148, v154, v155
    s_nop 1
    v_mov_b32_dpp v108, v148 row_newbcast:0 row_mask:0xf bank_mask:0xf
    v_mov_b32_dpp v109, v148 row_newbcast:1 row_mask:0xf bank_mask:0xf
    v_mov_b32_dpp v110, v148 row_newbcast:2 row_mask:0xf bank_mask:0xf
    v_mov_b32_dpp v111, v148 row_newbcast:3 row_mask:0xf bank_mask:0xf
    v_mov_b32_dpp v112, v148 row_newbcast:4 row_mask:0xf bank_mask:0xf
    v_mov_b32_dpp v113, v148 row_newbcast:5 row_mask:0xf bank_mask:0xf
    v_mov_b32_dpp v114, v148 row_newbcast:6 row_mask:0xf bank_mask:0xf
    v_mov_b32_dpp v115, v148 row_newbcast:7 row_mask:0xf bank_mask:0xf
    v_mfma_f32_16x16x32_bf16 v[124:127], v[108:111], v[40:43], 0
    v_mov_b32_dpp v116, v148 row_newbcast:8 row_mask:0xf bank_mask:0xf
    v_mfma_f32_16x16x32_bf16 v[128:131], v[108:111], v[44:47], 0
    v_mov_b32_dpp v117, v148 row_newbcast:9 row_mask:0xf bank_mask:0xf
    v_mfma_f32_16x16x32_bf16 v[132:135], v[108:111], v[48:51], 0
    v_mov_b32_dpp v118, v148 row_newbcast:10 row_mask:0xf bank_mask:0xf
    v_mfma_f32_16x16x32_bf16 v[136:139], v[108:111], v[52:55], 0
    v_mov_b32_dpp v119, v148 row_newbcast:11 row_mask:0xf bank_mask:0xf
    v_mfma_f32_16x16x32_bf16 v[124:127], v[112:115], v[56:59], v[124:127]
    v_mov_b32_dpp v120, v148 row_newbcast:12 row_mask:0xf bank_mask:0xf
    v_mfma_f32_16x16x32_bf16 v[128:131], v[112:115], v[60:63], v[128:131]
    v_mov_b32_dpp v121, v148 row_newbcast:13 row_mask:0xf bank_mask:0xf
    v_mfma_f32_16x16x32_bf16 v[132:135], v[112:115], v[64:67], v[132:135]
    v_mov_b32_dpp v122, v148 row_newbcast:14 row_mask:0xf bank_mask:0xf
    v_mfma_f32_16x16x32_bf16 v[136:139], v[112:115], v[68:71], v[136:139]
    v_mov_b32_dpp v123, v148 row_newbcast:15 row_mask:0xf bank_mask:0xf
    v_mfma_f32_16x16x32_bf16 v[124:127], v[116:119], v[72:75], v[124:127]
    v_mfma_f32_16x16x32_bf16 v[128:131], v[116:119], v[76:79], v[128:131]
    v_mfma_f32_16x16x32_bf16 v[132:135], v[116:119], v[80:83], v[132:135]
    v_mfma_f32_16x16x32_bf16 v[136:139], v[116:119], v[84:87], v[136:139]
    v_mfma_f32_16x16x32_bf16 v[124:127], v[120:123], v[88:91], v[124:127]
    v_mfma_f32_16x16x32_bf16 v[128:131], v[120:123], v[92:95], v[128:131]
    v_mfma_f32_16x16x32_bf16 v[132:135], v[120:123], v[96:99], v[132:135]
    v_mfma_f32_16x16x32_bf16 v[136:139], v[120:123], v[100:103], v[136:139]
    s_nop 5
    v_cndmask_b32 v158, v124, v128, s[68:69]
    v_cndmask_b32 v158, v158, v132, s[70:71]
    v_cndmask_b32 v158, v158, v136, s[72:73]
    ds_write_b32 v151, v158 offset:8192
    s_waitcnt lgkmcnt(0)
    s_barrier
    s_cmp_lg_u32 s3, 0
    s_cbranch_scc1 L_wo_done
    ds_read_b32 v160, v150 offset:8192
    ds_read_b32 v161, v150 offset:8448
    ds_read_b32 v162, v150 offset:8704
    ds_read_b32 v163, v150 offset:8960
    s_waitcnt lgkmcnt(0)
    v_add_f32 v160, v160, v161
    v_add_f32 v162, v162, v163
    v_add_f32 v160, v160, v162
    buffer_store_dword v160, v150, s[40:43], s55 offen sc1
L_wo_done:
    s_add_u32 s3, s3, 8
    s_endpgm
L_exit:
    s_endpgm
.section .rodata,"a"
.p2align 6
.amdhsa_kernel adaLN_cond__gqa_block_cached__dense_activation_relu__decode_kernel
  .amdhsa_next_free_vgpr 168
  .amdhsa_next_free_sgpr 102
  .amdhsa_accum_offset 168
  .amdhsa_group_segment_fixed_size 0
  .amdhsa_kernarg_size 104
  .amdhsa_user_sgpr_count 2
  .amdhsa_user_sgpr_kernarg_segment_ptr 1
  .amdhsa_system_sgpr_workgroup_id_x 1
.end_amdhsa_kernel
```
